```python
import torch

def _softmax(x, axis=-1):
    return torch.softmax(x, dim=axis)
def _gelu(x):
    return torch.nn.functional.gelu(x, approximate="tanh")
def _silu(x):
    return torch.nn.functional.silu(x)
def _sigmoid(x):
    return torch.sigmoid(x)
def _layernorm(x, axis=-1, eps=1e-5):
    m = x.mean(dim=axis, keepdim=True)
    v = x.var(dim=axis, keepdim=True, unbiased=False)
    return (x - m) / torch.sqrt(v + eps)
def _scatter_add(tgt, idx, src, axis=0):
    return tgt.clone().index_add_(axis, idx, src)
def _segment_sum(src, seg, n):
    out = torch.zeros((n,) + src.shape[1:], dtype=src.dtype)
    return out.index_add_(0, seg, src)
def _pad(x, pw):
    flat = tuple(v for pair in reversed(pw) for v in pair)
    return torch.nn.functional.pad(x, flat)

kernel_name = 'recurrent_scan__gqa_block_cached__geglu_ffn__decode'

def setup_inputs():

    _w = (lambda a: (lambda t: t.to(torch.bfloat16) if t.is_floating_point() else t)(torch.as_tensor(a)))
    def _A_setup():
        B, Sq, D = 1, 1, 640
        Hq, Hkv, Sk, Dh = 32, 32, 32768, 128
        assert Hq % Hkv == 0, (Hq, Hkv)
        return {
            "x": _w((lambda *s: torch.randn(*s, dtype=torch.bfloat16) * 0.05)(B, Sq, D)),
            "k_cache": _w((lambda *s: torch.randn(*s, dtype=torch.bfloat16) * 3.2)(B, Hkv, Sk, Dh)),
            "v_cache": _w((lambda *s: torch.randn(*s, dtype=torch.bfloat16) * 0.8)(B, Hkv, Sk, Dh)),
            "wq": _w((lambda *s: torch.randn(*s, dtype=torch.bfloat16) * 3.2)(D, Hq * Dh) * (D ** -0.5)),
            "wo": _w((lambda *s: torch.randn(*s, dtype=torch.bfloat16) * 0.8)(Hq * Dh, D) * ((Hq * Dh) ** -0.5)),
        }
    _A_in = _A_setup()

    def _B_setup():
        B, S, D, F = 1, 1, 640, 1728
        return {
            "x": _w((lambda *s: torch.randn(*s, dtype=torch.bfloat16) * 0.05)(B, S, D)),
            "w_gate": _w((lambda *s: torch.randn(*s, dtype=torch.bfloat16) * 0.4)(D, F)),
            "w_up": _w((lambda *s: torch.randn(*s, dtype=torch.bfloat16) * 0.4)(D, F)),
            "w_down": _w((lambda *s: torch.randn(*s, dtype=torch.bfloat16) * 0.4)(F, D)),
        }
    _B_in = _B_setup()

    return {
        "A_x": _A_in["x"],
        "A_k_cache": _A_in["k_cache"],
        "A_v_cache": _A_in["v_cache"],
        "A_wq": _A_in["wq"],
        "A_wo": _A_in["wo"],
        "B_x": _B_in["x"],
        "B_w_gate": _B_in["w_gate"],
        "B_w_up": _B_in["w_up"],
        "B_w_down": _B_in["w_down"],
    }

def reference(A_x, A_k_cache, A_v_cache, A_wq, A_wo, B_x, B_w_gate, B_w_up, B_w_down):
    def _A_ref(x, k_cache, v_cache, wq, wo):
        B, Sq, D = x.shape
        Hq, Dh = 32, 128
        Hkv = k_cache.shape[1]
        rep = Hq // Hkv
        q = (lambda x, *d: x.permute(*d))((x @ wq).reshape(B, Sq, Hq, Dh), 0, 2, 1, 3)
        k = (lambda x, n, axis: torch.repeat_interleave(x, n, dim=axis))(k_cache, rep, axis=1)
        v = (lambda x, n, axis: torch.repeat_interleave(x, n, dim=axis))(v_cache, rep, axis=1)
        scores = torch.einsum("bhqd,bhkd->bhqk", q, k) * (Dh ** -0.5)
        p = _softmax(scores, axis=-1)
        o = torch.einsum("bhqk,bhkd->bhqd", p, v)
        return (lambda x, *d: x.permute(*d))(o, 0, 2, 1, 3).reshape(B, Sq, Hq * Dh) @ wo

    def _B_ref(x, w_gate, w_up, w_down):
        return (_gelu(x @ w_gate) * (x @ w_up)) @ w_down

    x = A_x
    xn = _layernorm(x, axis=-1)
    s = _A_ref(xn, A_k_cache, A_v_cache, A_wq, A_wo)
    g = _silu(_B_ref(xn, B_w_gate, B_w_up, B_w_down))
    return x + s * g
```

```asm
; @launch grid=(256,1,1) block=(320,1,1) lds=155648
.amdgcn_target "amdgcn-amd-amdhsa--gfx950"
.text
.globl recurrent_scan__gqa_block_cached__geglu_ffn__decode_kernel
.p2align 8
.type recurrent_scan__gqa_block_cached__geglu_ffn__decode_kernel,@function
recurrent_scan__gqa_block_cached__geglu_ffn__decode_kernel:
    s_load_dwordx16 s[16:31], s[0:1], 0
    s_load_dwordx8 s[32:39], s[0:1], 64
    s_cmp_ge_u32 s2, 256
    s_cbranch_scc1 L_end
    v_lshrrev_b32 v34, 6, v0
    v_and_b32 v1, 63, v0
    v_readfirstlane_b32 s5, v34
    v_lshlrev_b32 v3, 2, v1
    v_mov_b32 v10, -1
    s_lshr_b32 s3, s2, 3
    s_and_b32 s4, s2, 7
    s_cmp_ge_u32 s5, 4
    s_cbranch_scc1 L_helper
    ds_write_b32 v3, v10 offset:2048
    ds_write_b32 v3, v10 offset:1024
    ds_write_b32 v3, v10 offset:1536
    v_lshlrev_b32 v2, 4, v1
    v_add_u32 v3, 0x8000, v2
    s_lshl_b32 s7, s5, 12
    s_and_b32 s8, s4, 6
    s_lshl_b32 s84, s8, 20
    s_and_b32 s8, s4, 1
    s_lshl_b32 s8, s8, 14
    s_or_b32 s84, s84, s8
    s_or_b32 s84, s84, s7
    s_lshl_b32 s9, s3, 23
    s_mov_b32 s42, 0x800000
    s_mov_b32 s43, 0x20000
    s_waitcnt lgkmcnt(0)
    s_add_u32 s40, s18, s9
    s_addc_u32 s41, s19, 0
    buffer_load_dwordx4 v[40:43], v2, s[40:43], s84 offen offset:0 nt
    buffer_load_dwordx4 v[44:47], v2, s[40:43], s84 offen offset:1024 nt
    buffer_load_dwordx4 v[48:51], v2, s[40:43], s84 offen offset:2048 nt
    buffer_load_dwordx4 v[52:55], v2, s[40:43], s84 offen offset:3072 nt
    buffer_load_dwordx4 v[56:59], v3, s[40:43], s84 offen offset:0 nt
    buffer_load_dwordx4 v[60:63], v3, s[40:43], s84 offen offset:1024 nt
    buffer_load_dwordx4 v[64:67], v3, s[40:43], s84 offen offset:2048 nt
    buffer_load_dwordx4 v[68:71], v3, s[40:43], s84 offen offset:3072 nt
    s_barrier
    s_mov_b32 s86, s84
    v_and_b32 v38, 15, v1
    v_lshrrev_b32 v39, 4, v1
    s_add_u32 s44, s20, s9
    s_addc_u32 s45, s21, 0
    v_and_b32 v34, 1, v38
    v_lshlrev_b32 v34, 4, v34
    v_mov_b32 v35, 0xffff
    v_lshlrev_b32 v35, v34, v35
    v_bfe_u32 v34, v38, 1, 2
    v_cmp_eq_u32 vcc, 0, v34
    s_nop 1
    v_cndmask_b32 v4, 0, v35, vcc
    v_cmp_eq_u32 vcc, 1, v34
    s_nop 1
    v_cndmask_b32 v5, 0, v35, vcc
    v_cmp_eq_u32 vcc, 2, v34
    s_nop 1
    v_cndmask_b32 v6, 0, v35, vcc
    v_cmp_eq_u32 vcc, 3, v34
    s_nop 1
    v_cndmask_b32 v7, 0, v35, vcc
    v_lshlrev_b32 v104, 5, v38
    v_and_b32 v34, 1, v39
    v_lshl_add_u32 v104, v34, 4, v104
    s_lshl_b32 s8, s5, 9
    v_add_u32 v104, s8, v104
    s_mov_b32 s72, 0xaaaaaaaa
    s_mov_b32 s73, 0xaaaaaaaa
    s_mov_b32 s78, 0x3db504f3
    s_mov_b32 s13, 30
    s_mov_b32 s80, 1
    s_mov_b32 s14, 0
    v_mov_b32 v12, 0
    v_mov_b32 v13, 0
    v_mov_b32 v14, 0
    v_mov_b32 v15, 0
    v_mov_b32 v32, 0xff800000
    v_mov_b32 v33, 0
    v_mov_b32 v117, -1
    s_mul_i32 s7, s5, 32768
    s_add_u32 s7, s7, 24576
    v_add_u32 v105, s7, v2
    s_mov_b32 s77, s7
    s_add_u32 s6, s4, s3
    s_and_b32 s6, s6, 7
    s_sub_u32 s8, 7, s6
    s_lshl_b32 s8, s8, 5
    s_add_u32 s8, s8, s3
    s_mul_i32 s70, s8, 205
    s_lshr_b32 s70, s70, 10
    s_mul_i32 s71, s70, 5
    s_sub_u32 s71, s8, s71
    s_add_u32 s70, s70, 32
    s_cmp_lt_u32 s8, 70
    s_cselect_b32 s70, s70, 63
    s_cmp_lt_u32 s6, 5
    s_cselect_b32 s70, s3, s70
    s_cselect_b32 s71, s6, s71
    s_cselect_b32 s48, s24, s32
    s_cselect_b32 s49, s25, s33
    s_mov_b32 s50, 2211840
    s_cselect_b32 s50, 5242880, s50
    s_mov_b32 s51, 0x20000
    s_cselect_b32 s9, 7, 0
    s_mov_b32 s56, s38
    s_mov_b32 s57, s39
    s_mov_b32 s58, 1310720
    s_mov_b32 s59, 0x20000
    v_mul_u32_u24 v106, 1280, v39
    v_lshl_add_u32 v106, v38, 4, v106
    s_and_b32 s8, s70, 31
    s_lshl_b32 s8, s8, 2
    s_add_u32 s8, s8, s5
    s_mul_i32 s76, s8, 40960
    s_lshl_b32 s8, s71, 8
    s_add_u32 s76, s76, s8
    v_lshrrev_b32 v35, 2, v38
    v_lshl_add_u32 v35, v39, 3, v35
    v_lshlrev_b32 v35, 8, v35
    v_and_b32 v36, 3, v38
    v_lshl_add_u32 v35, v36, 3, v35
    s_lshl_b32 s8, s5, 6
    s_add_u32 s8, s8, 24576
    v_add_u32 v107, s8, v35
    v_add_u32 v108, 65536, v107
    s_lshl_b32 s8, s5, 1
    v_lshrrev_b32 v35, 5, v1
    v_add_u32 v35, s8, v35
    v_and_b32 v36, 31, v1
    v_lshlrev_b32 v36, 3, v36
    v_mul_u32_u24 v120, 272, v35
    v_add_u32 v120, v120, v36
    v_and_b32 v35, s9, v35
    v_lshl_add_u32 v109, v35, 8, v36
    v_and_b32 v35, 7, v38
    v_mul_u32_u24 v121, 272, v35
    v_lshl_add_u32 v121, v39, 4, v121
    v_lshl_add_u32 v36, v39, 2, v38
    v_and_b32 v36, s9, v36
    v_lshlrev_b32 v110, 3, v36
    v_lshlrev_b32 v111, 2, v1
    v_lshrrev_b32 v35, 2, v1
    v_lshlrev_b32 v112, 3, v35
    v_and_b32 v35, 1, v1
    v_lshl_add_u32 v112, v35, 2, v112
    s_lshl_b32 s8, s5, 12
    v_add_u32 v112, s8, v112
    v_mov_b32 v114, v112
    v_add_u32 v113, 128, v112
    s_lshl_b32 s8, s5, 2
    v_mov_b32 v118, s8
    v_lshlrev_b32 v119, 1, v118
    s_lshl_b32 s79, s70, 12
    s_add_u32 s79, s79, 65536
    s_mul_i32 s15, s70, 2560
    s_lshl_b32 s8, s71, 9
    s_add_u32 s15, s15, s8
    s_lshl_b32 s8, s5, 7
    s_add_u32 s15, s15, s8
    s_add_u32 s15, s15, 262144
    s_cmp_lt_u32 s70, 46
    s_cselect_b32 s50, s50, 0
    s_add_u32 s84, s84, 0x10000
    s_lshr_b32 s12, s84, 5
    s_and_b32 s12, s12, 0x4000
    s_xor_b32 s12, s12, s84
    s_waitcnt vmcnt(4)
    buffer_load_dwordx4 v[72:75], v2, s[40:43], s12 offen offset:0 nt
    s_waitcnt vmcnt(4)
    buffer_load_dwordx4 v[76:79], v2, s[40:43], s12 offen offset:1024 nt
    s_waitcnt vmcnt(4)
    buffer_load_dwordx4 v[80:83], v2, s[40:43], s12 offen offset:2048 nt
    s_waitcnt vmcnt(4)
    buffer_load_dwordx4 v[84:87], v2, s[40:43], s12 offen offset:3072 nt
    s_waitcnt vmcnt(4)
    buffer_load_dwordx4 v[88:91], v3, s[40:43], s12 offen offset:0 nt
    s_waitcnt vmcnt(4)
    buffer_load_dwordx4 v[92:95], v3, s[40:43], s12 offen offset:1024 nt
    s_waitcnt vmcnt(4)
    buffer_load_dwordx4 v[96:99], v3, s[40:43], s12 offen offset:2048 nt
    s_waitcnt vmcnt(4)
    buffer_load_dwordx4 v[100:103], v3, s[40:43], s12 offen offset:3072 nt
    s_add_u32 s8, s7, 32768
    v_lshlrev_b32 v34, 4, v38
L_bk:
    ds_read_b128 v[8:11], v34 offset:2048
    s_waitcnt lgkmcnt(0)
    v_max_u32 v35, v8, v9
    v_max3_u32 v35, v35, v10, v11
    v_cmp_eq_u32 vcc, -1, v35
    s_cbranch_vccz L_go
    s_cmp_lt_u32 s7, s8
    s_cbranch_scc0 L_bk
    s_add_u32 s84, s84, 0x10000
    s_lshr_b32 s12, s84, 5
    s_and_b32 s12, s12, 0x4000
    s_xor_b32 s12, s12, s84
    s_mov_b32 m0, s7
    s_waitcnt vmcnt(4)
    buffer_load_dwordx4 v2, s[40:43], s12 offen offset:0 nt lds
    s_waitcnt vmcnt(4)
    buffer_load_dwordx4 v2, s[40:43], s12 offen offset:1024 nt lds
    s_waitcnt vmcnt(4)
    buffer_load_dwordx4 v2, s[40:43], s12 offen offset:2048 nt lds
    s_waitcnt vmcnt(4)
    buffer_load_dwordx4 v2, s[40:43], s12 offen offset:3072 nt lds
    s_add_u32 m0, s7, 4096
    s_waitcnt vmcnt(4)
    buffer_load_dwordx4 v3, s[40:43], s12 offen offset:0 nt lds
    s_waitcnt vmcnt(4)
    buffer_load_dwordx4 v3, s[40:43], s12 offen offset:1024 nt lds
    s_waitcnt vmcnt(4)
    buffer_load_dwordx4 v3, s[40:43], s12 offen offset:2048 nt lds
    s_waitcnt vmcnt(4)
    buffer_load_dwordx4 v3, s[40:43], s12 offen offset:3072 nt lds
    s_add_u32 s7, s7, 8192
    s_add_u32 s80, s80, 1
    s_sub_u32 s13, s13, 1
    s_branch L_bk
L_go:
    s_add_u32 s69, s80, 1
    s_lshl_b32 s69, s69, 7
    s_add_u32 s8, s13, 32
    v_mov_b32 v116, s8
    s_mov_b32 s62, 0x40000000
L_loopK:
    s_cmp_eq_u32 s13, 0
    s_cbranch_scc1 L_lastK
    s_add_u32 s84, s84, 0x10000
    s_lshr_b32 s12, s84, 5
    s_and_b32 s12, s12, 0x4000
    s_xor_b32 s12, s12, s84
L_bodyK:
    s_sub_u32 s13, s13, 1
    s_waitcnt lgkmcnt(0)
    v_readfirstlane_b32 s7, v117
    v_add_u32 v116, -1, v116
    v_lshlrev_b32 v37, 2, v116
    ds_write_b32 v118, v116 offset:1024
    ds_read_b32 v117, v37 offset:1532
    s_sub_u32 s7, s62, s7
    s_add_u32 s8, s7, 4000
    s_cmp_lt_u32 s8, 3935
    s_cbranch_scc1 L_slowk
    s_sub_u32 s8, s7, 5
    s_cmp_lt_u32 s8, 4000
    s_cbranch_scc1 L_widek
    s_waitcnt vmcnt(4)
    v_dot2_f32_bf16 v24, v40, v8, 0
    v_dot2_f32_bf16 v24, v41, v9, v24
    v_dot2_f32_bf16 v24, v42, v10, v24
    v_dot2_f32_bf16 v24, v43, v11, v24
    buffer_load_dwordx4 v[40:43], v2, s[40:43], s12 offen offset:0 nt
    s_waitcnt vmcnt(4)
    v_dot2_f32_bf16 v25, v44, v8, 0
    v_dot2_f32_bf16 v25, v45, v9, v25
    v_dot2_f32_bf16 v25, v46, v10, v25
    v_dot2_f32_bf16 v25, v47, v11, v25
    buffer_load_dwordx4 v[44:47], v2, s[40:43], s12 offen offset:1024 nt
    s_waitcnt vmcnt(4)
    v_dot2_f32_bf16 v26, v48, v8, 0
    v_dot2_f32_bf16 v26, v49, v9, v26
    v_dot2_f32_bf16 v26, v50, v10, v26
    v_dot2_f32_bf16 v26, v51, v11, v26
    buffer_load_dwordx4 v[48:51], v2, s[40:43], s12 offen offset:2048 nt
    s_waitcnt vmcnt(4)
    v_dot2_f32_bf16 v27, v52, v8, 0
    v_dot2_f32_bf16 v27, v53, v9, v27
    v_dot2_f32_bf16 v27, v54, v10, v27
    v_dot2_f32_bf16 v27, v55, v11, v27
    buffer_load_dwordx4 v[52:55], v2, s[40:43], s12 offen offset:3072 nt
    s_waitcnt vmcnt(4)
    v_dot2_f32_bf16 v28, v56, v8, 0
    v_dot2_f32_bf16 v28, v57, v9, v28
    v_dot2_f32_bf16 v28, v58, v10, v28
    v_dot2_f32_bf16 v28, v59, v11, v28
    buffer_load_dwordx4 v[56:59], v3, s[40:43], s12 offen offset:0 nt
    s_waitcnt vmcnt(4)
    v_dot2_f32_bf16 v29, v60, v8, 0
    v_dot2_f32_bf16 v29, v61, v9, v29
    v_dot2_f32_bf16 v29, v62, v10, v29
    v_dot2_f32_bf16 v29, v63, v11, v29
    buffer_load_dwordx4 v[60:63], v3, s[40:43], s12 offen offset:1024 nt
    s_waitcnt vmcnt(4)
    v_dot2_f32_bf16 v30, v64, v8, 0
    v_dot2_f32_bf16 v30, v65, v9, v30
    v_dot2_f32_bf16 v30, v66, v10, v30
    v_dot2_f32_bf16 v30, v67, v11, v30
    buffer_load_dwordx4 v[64:67], v3, s[40:43], s12 offen offset:2048 nt
    s_waitcnt vmcnt(4)
    v_dot2_f32_bf16 v31, v68, v8, 0
    v_dot2_f32_bf16 v31, v69, v9, v31
    v_dot2_f32_bf16 v31, v70, v10, v31
    v_dot2_f32_bf16 v31, v71, v11, v31
    buffer_load_dwordx4 v[68:71], v3, s[40:43], s12 offen offset:3072 nt
    s_memrealtime s[62:63]
    v_add_f32_dpp v24, v24, v24 row_ror:8 row_mask:0xf bank_mask:0x3
    v_add_f32_dpp v25, v25, v25 row_ror:8 row_mask:0xf bank_mask:0x3
    v_add_f32_dpp v26, v26, v26 row_ror:8 row_mask:0xf bank_mask:0x3
    v_add_f32_dpp v27, v27, v27 row_ror:8 row_mask:0xf bank_mask:0x3
    v_add_f32_dpp v24, v28, v28 row_ror:8 row_mask:0xf bank_mask:0xc
    v_add_f32_dpp v25, v29, v29 row_ror:8 row_mask:0xf bank_mask:0xc
    v_add_f32_dpp v26, v30, v30 row_ror:8 row_mask:0xf bank_mask:0xc
    v_add_f32_dpp v27, v31, v31 row_ror:8 row_mask:0xf bank_mask:0xc
    v_add_f32_dpp v24, v24, v24 row_half_mirror row_mask:0xf bank_mask:0x5
    v_add_f32_dpp v25, v25, v25 row_half_mirror row_mask:0xf bank_mask:0x5
    s_nop 0
    v_add_f32_dpp v24, v26, v26 row_half_mirror row_mask:0xf bank_mask:0xa
    v_add_f32_dpp v25, v27, v27 row_half_mirror row_mask:0xf bank_mask:0xa
    s_nop 0
    v_add_f32_dpp v24, v24, v24 quad_perm:[1,0,3,2] row_mask:0xf bank_mask:0xf
    v_add_f32_dpp v25, v25, v25 quad_perm:[1,0,3,2] row_mask:0xf bank_mask:0xf
    v_cndmask_b32 v24, v24, v25, s[72:73]
    s_nop 1
    v_add_f32_dpp v24, v24, v24 quad_perm:[2,3,0,1] row_mask:0xf bank_mask:0xf
    v_cvt_pk_bf16_f32 v34, v24, v24
    v_and_b32 v34, 0xffff0000, v34
    v_mul_f32 v34, s78, v34
    v_cvt_pk_bf16_f32 v34, v34, v34
    v_and_b32 v34, 0xffff0000, v34
    ds_write_b32 v112, v34 offset:8192
    v_max_f32 v32, v32, v34
L_joink:
    v_add_u32 v112, s69, v112
    s_mov_b32 s69, 128
    s_cmp_lg_u32 s80, 0
    s_cbranch_scc1 L_extra
    s_cmp_lg_u32 s13, -1
    s_cbranch_scc1 L_loopK
    ds_read_b32 v115, v114 offset:8192
    v_add_u32 v114, 128, v114
    v_max_f32_dpp v32, v32, v32 row_ror:8 row_mask:0xf bank_mask:0xf
    s_nop 1
    v_max_f32_dpp v32, v32, v32 row_ror:4 row_mask:0xf bank_mask:0xf
    s_nop 1
    v_max_f32_dpp v32, v32, v32 row_ror:2 row_mask:0xf bank_mask:0xf
    s_nop 1
    v_max_f32_dpp v32, v32, v32 row_ror:1 row_mask:0xf bank_mask:0xf
    v_mov_b32 v35, v32
    s_nop 1
    v_permlane16_swap_b32 v35, v32
    v_max_f32 v32, v32, v35
    v_mov_b32 v35, v32
    s_nop 1
    v_permlane32_swap_b32 v35, v32
    v_max_f32 v32, v32, v35
    s_mov_b32 s13, 31
L_loopV:
    s_add_u32 s84, s84, 0x10000
    s_lshr_b32 s12, s84, 5
    s_and_b32 s12, s12, 0x4000
    s_xor_b32 s12, s12, s84
    s_sub_u32 s13, s13, 1
    s_waitcnt lgkmcnt(0)
    v_readfirstlane_b32 s7, v117
    v_add_u32 v116, -1, v116
    v_lshlrev_b32 v37, 2, v116
    ds_write_b32 v118, v116 offset:1024
    ds_read_b32 v117, v37 offset:1532
    s_sub_u32 s7, s62, s7
    s_add_u32 s8, s7, 4000
    s_cmp_lt_u32 s8, 3935
    s_cbranch_scc1 L_slowv
    s_sub_u32 s8, s7, 5
    s_cmp_lt_u32 s8, 4000
    s_cbranch_scc1 L_widev
    v_sub_f32 v35, v115, v32
    ds_read_b32 v115, v114 offset:8192
    v_add_u32 v114, 128, v114
    v_mul_f32 v35, 0x3fb8aa3b, v35
    v_exp_f32 v35, v35
    s_nop 0
    v_cvt_pk_bf16_f32 v36, v35, v35
    v_add_f32 v33, v33, v35
    s_nop 0
    v_and_b32_dpp v16, v36, v4 row_newbcast:0 row_mask:0xf bank_mask:0xf
    v_and_b32_dpp v17, v36, v5 row_newbcast:0 row_mask:0xf bank_mask:0xf
    v_and_b32_dpp v18, v36, v6 row_newbcast:0 row_mask:0xf bank_mask:0xf
    v_and_b32_dpp v19, v36, v7 row_newbcast:0 row_mask:0xf bank_mask:0xf
    v_and_b32_dpp v20, v36, v4 row_newbcast:1 row_mask:0xf bank_mask:0xf
    v_and_b32_dpp v21, v36, v5 row_newbcast:1 row_mask:0xf bank_mask:0xf
    v_and_b32_dpp v22, v36, v6 row_newbcast:1 row_mask:0xf bank_mask:0xf
    v_and_b32_dpp v23, v36, v7 row_newbcast:1 row_mask:0xf bank_mask:0xf
    s_waitcnt vmcnt(4)
    v_mfma_f32_16x16x32_bf16 v[12:15], v[16:19], v[40:43], v[12:15]
    buffer_load_dwordx4 v[40:43], v2, s[40:43], s12 offen offset:0 nt
    v_and_b32_dpp v16, v36, v4 row_newbcast:4 row_mask:0xf bank_mask:0xf
    v_and_b32_dpp v17, v36, v5 row_newbcast:4 row_mask:0xf bank_mask:0xf
    v_and_b32_dpp v18, v36, v6 row_newbcast:4 row_mask:0xf bank_mask:0xf
    v_and_b32_dpp v19, v36, v7 row_newbcast:4 row_mask:0xf bank_mask:0xf
    s_waitcnt vmcnt(4)
    v_mfma_f32_16x16x32_bf16 v[12:15], v[20:23], v[44:47], v[12:15]
    buffer_load_dwordx4 v[44:47], v2, s[40:43], s12 offen offset:1024 nt
    v_and_b32_dpp v20, v36, v4 row_newbcast:5 row_mask:0xf bank_mask:0xf
    v_and_b32_dpp v21, v36, v5 row_newbcast:5 row_mask:0xf bank_mask:0xf
    v_and_b32_dpp v22, v36, v6 row_newbcast:5 row_mask:0xf bank_mask:0xf
    v_and_b32_dpp v23, v36, v7 row_newbcast:5 row_mask:0xf bank_mask:0xf
    s_waitcnt vmcnt(4)
    v_mfma_f32_16x16x32_bf16 v[12:15], v[16:19], v[48:51], v[12:15]
    buffer_load_dwordx4 v[48:51], v2, s[40:43], s12 offen offset:2048 nt
    v_and_b32_dpp v16, v36, v4 row_newbcast:8 row_mask:0xf bank_mask:0xf
    v_and_b32_dpp v17, v36, v5 row_newbcast:8 row_mask:0xf bank_mask:0xf
    v_and_b32_dpp v18, v36, v6 row_newbcast:8 row_mask:0xf bank_mask:0xf
    v_and_b32_dpp v19, v36, v7 row_newbcast:8 row_mask:0xf bank_mask:0xf
    s_waitcnt vmcnt(4)
    v_mfma_f32_16x16x32_bf16 v[12:15], v[20:23], v[52:55], v[12:15]
    buffer_load_dwordx4 v[52:55], v2, s[40:43], s12 offen offset:3072 nt
    v_and_b32_dpp v20, v36, v4 row_newbcast:9 row_mask:0xf bank_mask:0xf
    v_and_b32_dpp v21, v36, v5 row_newbcast:9 row_mask:0xf bank_mask:0xf
    v_and_b32_dpp v22, v36, v6 row_newbcast:9 row_mask:0xf bank_mask:0xf
    v_and_b32_dpp v23, v36, v7 row_newbcast:9 row_mask:0xf bank_mask:0xf
    s_waitcnt vmcnt(4)
    v_mfma_f32_16x16x32_bf16 v[12:15], v[16:19], v[56:59], v[12:15]
    buffer_load_dwordx4 v[56:59], v3, s[40:43], s12 offen offset:0 nt
    v_and_b32_dpp v16, v36, v4 row_newbcast:12 row_mask:0xf bank_mask:0xf
    v_and_b32_dpp v17, v36, v5 row_newbcast:12 row_mask:0xf bank_mask:0xf
    v_and_b32_dpp v18, v36, v6 row_newbcast:12 row_mask:0xf bank_mask:0xf
    v_and_b32_dpp v19, v36, v7 row_newbcast:12 row_mask:0xf bank_mask:0xf
    s_waitcnt vmcnt(4)
    v_mfma_f32_16x16x32_bf16 v[12:15], v[20:23], v[60:63], v[12:15]
    buffer_load_dwordx4 v[60:63], v3, s[40:43], s12 offen offset:1024 nt
    v_and_b32_dpp v20, v36, v4 row_newbcast:13 row_mask:0xf bank_mask:0xf
    v_and_b32_dpp v21, v36, v5 row_newbcast:13 row_mask:0xf bank_mask:0xf
    v_and_b32_dpp v22, v36, v6 row_newbcast:13 row_mask:0xf bank_mask:0xf
    v_and_b32_dpp v23, v36, v7 row_newbcast:13 row_mask:0xf bank_mask:0xf
    s_waitcnt vmcnt(4)
    v_mfma_f32_16x16x32_bf16 v[12:15], v[16:19], v[64:67], v[12:15]
    buffer_load_dwordx4 v[64:67], v3, s[40:43], s12 offen offset:2048 nt
    s_waitcnt vmcnt(4)
    v_mfma_f32_16x16x32_bf16 v[12:15], v[20:23], v[68:71], v[12:15]
    s_memrealtime s[62:63]
    buffer_load_dwordx4 v[68:71], v3, s[40:43], s12 offen offset:3072 nt
L_joinv:
    s_cmp_lg_u32 s13, 0
    s_cbranch_scc1 L_loopV
L_lastV:
    s_waitcnt lgkmcnt(0)
    v_sub_f32 v35, v115, v32
    v_mul_f32 v35, 0x3fb8aa3b, v35
    v_exp_f32 v35, v35
    s_nop 0
    v_cvt_pk_bf16_f32 v36, v35, v35
    v_add_f32 v33, v33, v35
    s_nop 0
    v_and_b32_dpp v16, v36, v4 row_newbcast:0 row_mask:0xf bank_mask:0xf
    v_and_b32_dpp v17, v36, v5 row_newbcast:0 row_mask:0xf bank_mask:0xf
    v_and_b32_dpp v18, v36, v6 row_newbcast:0 row_mask:0xf bank_mask:0xf
    v_and_b32_dpp v19, v36, v7 row_newbcast:0 row_mask:0xf bank_mask:0xf
    v_and_b32_dpp v20, v36, v4 row_newbcast:1 row_mask:0xf bank_mask:0xf
    v_and_b32_dpp v21, v36, v5 row_newbcast:1 row_mask:0xf bank_mask:0xf
    v_and_b32_dpp v22, v36, v6 row_newbcast:1 row_mask:0xf bank_mask:0xf
    v_and_b32_dpp v23, v36, v7 row_newbcast:1 row_mask:0xf bank_mask:0xf
    v_add_f32_dpp v33, v33, v33 quad_perm:[1,0,3,2] row_mask:0xf bank_mask:0xf
    s_nop 1
    v_add_f32_dpp v33, v33, v33 row_ror:8 row_mask:0xf bank_mask:0xf
    s_nop 1
    v_add_f32_dpp v33, v33, v33 row_ror:4 row_mask:0xf bank_mask:0xf
    v_mov_b32 v35, v33
    s_nop 1
    v_permlane16_swap_b32 v35, v33
    v_add_f32 v33, v33, v35
    v_mov_b32 v35, v33
    s_nop 1
    v_permlane32_swap_b32 v35, v33
    v_add_f32 v33, v33, v35
    ds_write_b64 v119, v[32:33] offset:4352
    s_waitcnt lgkmcnt(0)
    s_barrier
    s_waitcnt vmcnt(7)
    v_mfma_f32_16x16x32_bf16 v[12:15], v[16:19], v[40:43], v[12:15]
    s_mov_b32 m0, s77
    s_add_u32 s77, s77, 1024
    buffer_load_dwordx4 v106, s[48:51], s76 offen nt lds
    s_add_u32 s76, s76, 5120
    v_and_b32_dpp v16, v36, v4 row_newbcast:4 row_mask:0xf bank_mask:0xf
    v_and_b32_dpp v17, v36, v5 row_newbcast:4 row_mask:0xf bank_mask:0xf
    v_and_b32_dpp v18, v36, v6 row_newbcast:4 row_mask:0xf bank_mask:0xf
    v_and_b32_dpp v19, v36, v7 row_newbcast:4 row_mask:0xf bank_mask:0xf
    s_waitcnt vmcnt(7)
    v_mfma_f32_16x16x32_bf16 v[12:15], v[20:23], v[44:47], v[12:15]
    s_mov_b32 m0, s77
    s_add_u32 s77, s77, 1024
    buffer_load_dwordx4 v106, s[48:51], s76 offen nt lds
    s_add_u32 s76, s76, 5120
    v_and_b32_dpp v20, v36, v4 row_newbcast:5 row_mask:0xf bank_mask:0xf
    v_and_b32_dpp v21, v36, v5 row_newbcast:5 row_mask:0xf bank_mask:0xf
    v_and_b32_dpp v22, v36, v6 row_newbcast:5 row_mask:0xf bank_mask:0xf
    v_and_b32_dpp v23, v36, v7 row_newbcast:5 row_mask:0xf bank_mask:0xf
    s_waitcnt vmcnt(7)
    v_mfma_f32_16x16x32_bf16 v[12:15], v[16:19], v[48:51], v[12:15]
    s_mov_b32 m0, s77
    s_add_u32 s77, s77, 1024
    buffer_load_dwordx4 v106, s[48:51], s76 offen nt lds
    s_add_u32 s76, s76, 5120
    v_and_b32_dpp v16, v36, v4 row_newbcast:8 row_mask:0xf bank_mask:0xf
    v_and_b32_dpp v17, v36, v5 row_newbcast:8 row_mask:0xf bank_mask:0xf
    v_and_b32_dpp v18, v36, v6 row_newbcast:8 row_mask:0xf bank_mask:0xf
    v_and_b32_dpp v19, v36, v7 row_newbcast:8 row_mask:0xf bank_mask:0xf
    s_waitcnt vmcnt(7)
    v_mfma_f32_16x16x32_bf16 v[12:15], v[20:23], v[52:55], v[12:15]
    s_mov_b32 m0, s77
    s_add_u32 s77, s77, 1024
    buffer_load_dwordx4 v106, s[48:51], s76 offen nt lds
    s_add_u32 s76, s76, 5120
    v_and_b32_dpp v20, v36, v4 row_newbcast:9 row_mask:0xf bank_mask:0xf
    v_and_b32_dpp v21, v36, v5 row_newbcast:9 row_mask:0xf bank_mask:0xf
    v_and_b32_dpp v22, v36, v6 row_newbcast:9 row_mask:0xf bank_mask:0xf
    v_and_b32_dpp v23, v36, v7 row_newbcast:9 row_mask:0xf bank_mask:0xf
    s_waitcnt vmcnt(7)
    v_mfma_f32_16x16x32_bf16 v[12:15], v[16:19], v[56:59], v[12:15]
    v_and_b32_dpp v16, v36, v4 row_newbcast:12 row_mask:0xf bank_mask:0xf
    v_and_b32_dpp v17, v36, v5 row_newbcast:12 row_mask:0xf bank_mask:0xf
    v_and_b32_dpp v18, v36, v6 row_newbcast:12 row_mask:0xf bank_mask:0xf
    v_and_b32_dpp v19, v36, v7 row_newbcast:12 row_mask:0xf bank_mask:0xf
    s_waitcnt vmcnt(6)
    v_mfma_f32_16x16x32_bf16 v[12:15], v[20:23], v[60:63], v[12:15]
    v_and_b32_dpp v20, v36, v4 row_newbcast:13 row_mask:0xf bank_mask:0xf
    v_and_b32_dpp v21, v36, v5 row_newbcast:13 row_mask:0xf bank_mask:0xf
    v_and_b32_dpp v22, v36, v6 row_newbcast:13 row_mask:0xf bank_mask:0xf
    v_and_b32_dpp v23, v36, v7 row_newbcast:13 row_mask:0xf bank_mask:0xf
    s_waitcnt vmcnt(5)
    v_mfma_f32_16x16x32_bf16 v[12:15], v[16:19], v[64:67], v[12:15]
    s_waitcnt vmcnt(4)
    v_mfma_f32_16x16x32_bf16 v[12:15], v[20:23], v[68:71], v[12:15]
    s_mov_b32 m0, s77
    s_add_u32 s77, s77, 1024
    buffer_load_dwordx4 v106, s[48:51], s76 offen nt lds
    s_add_u32 s76, s76, 5120
    s_mov_b32 m0, s77
    s_add_u32 s77, s77, 1024
    buffer_load_dwordx4 v106, s[48:51], s76 offen nt lds
    s_add_u32 s76, s76, 5120
    ds_write_b128 v104, v[12:15] offset:2304
    s_mov_b32 m0, s77
    s_add_u32 s77, s77, 1024
    buffer_load_dwordx4 v106, s[48:51], s76 offen nt lds
    s_add_u32 s76, s76, 5120
    s_mov_b32 m0, s77
    s_add_u32 s77, s77, 1024
    buffer_load_dwordx4 v106, s[48:51], s76 offen nt lds
    s_add_u32 s76, s76, 5120
    s_waitcnt lgkmcnt(0)
    s_barrier
    s_cmp_lt_u32 s70, 46
    s_cbranch_scc0 L_sdone
    buffer_load_dwordx2 v[74:75], v110, s[56:59], s79 offen offset:2048 sc1
    s_waitcnt vmcnt(1)
    s_barrier
    buffer_load_dwordx2 v[72:73], v109, s[56:59], s79 offen sc1
    ds_read_b64_tr_b16 v[40:41], v107 offset:0
    ds_read_b64_tr_b16 v[42:43], v107 offset:1024
    ds_read_b64_tr_b16 v[44:45], v107 offset:32768
    ds_read_b64_tr_b16 v[46:47], v107 offset:33792
    ds_read_b64_tr_b16 v[48:49], v108 offset:0
    ds_read_b64_tr_b16 v[50:51], v108 offset:1024
    ds_read_b64_tr_b16 v[52:53], v108 offset:32768
    ds_read_b64_tr_b16 v[54:55], v108 offset:33792
    s_waitcnt lgkmcnt(4)
    ds_read_b64_tr_b16 v[56:57], v107 offset:32
    ds_read_b64_tr_b16 v[58:59], v107 offset:1056
    ds_read_b64_tr_b16 v[60:61], v107 offset:32800
    ds_read_b64_tr_b16 v[62:63], v107 offset:33824
    ds_read_b64_tr_b16 v[64:65], v108 offset:32
    ds_read_b64_tr_b16 v[66:67], v108 offset:1056
    ds_read_b64_tr_b16 v[68:69], v108 offset:32800
    ds_read_b64_tr_b16 v[70:71], v108 offset:33824
L_p0:
    s_waitcnt vmcnt(1)
    v_max_u32 v34, v74, v75
    v_cmp_eq_u32 vcc, -1, v34
    s_cbranch_vccz L_p0_ok
    s_waitcnt vmcnt(0)
    buffer_load_dwordx2 v[74:75], v110, s[56:59], s79 offen offset:2048 sc1
    buffer_load_dwordx2 v[72:73], v109, s[56:59], s79 offen sc1
    s_add_u32 s14, s14, 1
    s_cmp_gt_u32 s14, 1048576
    s_cbranch_scc0 L_p0
    s_waitcnt vmcnt(0)
L_p0_ok:
    v_max_f32_dpp v34, v74, v74 row_ror:4 row_mask:0xf bank_mask:0xf
    s_nop 1
    v_max_f32_dpp v34, v34, v34 row_ror:2 row_mask:0xf bank_mask:0xf
    s_nop 1
    v_max_f32_dpp v34, v34, v34 row_ror:1 row_mask:0xf bank_mask:0xf
    v_sub_f32 v34, v74, v34
    v_mul_f32 v34, 0x3fb8aa3b, v34
    v_exp_f32 v34, v34
    s_nop 0
    v_mul_f32 v34, v34, v75
    s_nop 1
    v_add_f32_dpp v35, v34, v34 row_ror:4 row_mask:0xf bank_mask:0xf
    s_nop 1
    v_add_f32_dpp v35, v35, v35 row_ror:2 row_mask:0xf bank_mask:0xf
    s_nop 1
    v_add_f32_dpp v35, v35, v35 row_ror:1 row_mask:0xf bank_mask:0xf
    v_rcp_f32 v35, v35
L_p1:
    s_waitcnt vmcnt(0)
    ds_write_b64 v120, v[72:73] offset:4608
    v_max_u32 v36, v72, v73
    v_cmp_eq_u32 vcc, -1, v36
    s_cbranch_vccz L_p1_ok
    s_waitcnt lgkmcnt(0)
    buffer_load_dwordx2 v[72:73], v109, s[56:59], s79 offen sc1
    s_add_u32 s14, s14, 1
    s_cmp_gt_u32 s14, 1048576
    s_cbranch_scc0 L_p1
L_p1_ok:
    s_waitcnt lgkmcnt(0)
    s_barrier
    ds_read_b128 v[16:19], v121 offset:4608
    ds_read_b128 v[20:23], v121 offset:4672
    ds_read_b128 v[24:27], v121 offset:4736
    ds_read_b128 v[28:31], v121 offset:4800
    s_waitcnt lgkmcnt(3)
    v_mfma_f32_16x16x32_bf16 v[8:11], v[16:19], v[40:43], 0
    v_mfma_f32_16x16x32_bf16 v[12:15], v[16:19], v[56:59], 0
    s_waitcnt lgkmcnt(2)
    v_mfma_f32_16x16x32_bf16 v[8:11], v[20:23], v[44:47], v[8:11]
    v_mfma_f32_16x16x32_bf16 v[12:15], v[20:23], v[60:63], v[12:15]
    s_waitcnt lgkmcnt(1)
    v_mfma_f32_16x16x32_bf16 v[8:11], v[24:27], v[48:51], v[8:11]
    v_mfma_f32_16x16x32_bf16 v[12:15], v[24:27], v[64:67], v[12:15]
    s_waitcnt lgkmcnt(0)
    v_mfma_f32_16x16x32_bf16 v[8:11], v[28:31], v[52:55], v[8:11]
    v_mfma_f32_16x16x32_bf16 v[12:15], v[28:31], v[68:71], v[12:15]
    s_nop 6
    v_mul_f32_dpp v36, v34, v8 row_newbcast:0 row_mask:0xf bank_mask:0xf
    v_mul_f32_dpp v37, v34, v12 row_newbcast:0 row_mask:0xf bank_mask:0xf
    s_nop 0
    v_fmac_f32_dpp v36, v34, v9 row_newbcast:1 row_mask:0xf bank_mask:0xf
    v_fmac_f32_dpp v37, v34, v13 row_newbcast:1 row_mask:0xf bank_mask:0xf
    s_nop 0
    v_fmac_f32_dpp v36, v34, v10 row_newbcast:2 row_mask:0xf bank_mask:0xf
    v_fmac_f32_dpp v37, v34, v14 row_newbcast:2 row_mask:0xf bank_mask:0xf
    s_nop 0
    v_fmac_f32_dpp v36, v34, v11 row_newbcast:3 row_mask:0xf bank_mask:0xf
    v_fmac_f32_dpp v37, v34, v15 row_newbcast:3 row_mask:0xf bank_mask:0xf
    s_nop 1
    v_permlane16_swap_b32 v36, v37
    v_add_f32 v36, v36, v37
    v_mul_f32 v36, v36, v35
    v_min_u32 v36, -2, v36
    s_mov_b32 exec_hi, 0
    buffer_store_dword v36, v111, s[56:59], s15 offen sc1
L_sdone:
    s_endpgm
L_lastK:
    s_mov_b32 s40, s44
    s_mov_b32 s41, s45
    s_mov_b32 s84, s86
    s_mov_b32 s12, s86
    s_branch L_bodyK
L_extra:
    s_waitcnt lgkmcnt(0)
    v_dot2_f32_bf16 v24, v72, v8, 0
    v_dot2_f32_bf16 v24, v73, v9, v24
    v_dot2_f32_bf16 v24, v74, v10, v24
    v_dot2_f32_bf16 v24, v75, v11, v24
    v_dot2_f32_bf16 v25, v76, v8, 0
    v_dot2_f32_bf16 v25, v77, v9, v25
    v_dot2_f32_bf16 v25, v78, v10, v25
    v_dot2_f32_bf16 v25, v79, v11, v25
    v_dot2_f32_bf16 v26, v80, v8, 0
    v_dot2_f32_bf16 v26, v81, v9, v26
    v_dot2_f32_bf16 v26, v82, v10, v26
    v_dot2_f32_bf16 v26, v83, v11, v26
    v_dot2_f32_bf16 v27, v84, v8, 0
    v_dot2_f32_bf16 v27, v85, v9, v27
    v_dot2_f32_bf16 v27, v86, v10, v27
    v_dot2_f32_bf16 v27, v87, v11, v27
    v_dot2_f32_bf16 v28, v88, v8, 0
    v_dot2_f32_bf16 v28, v89, v9, v28
    v_dot2_f32_bf16 v28, v90, v10, v28
    v_dot2_f32_bf16 v28, v91, v11, v28
    v_dot2_f32_bf16 v29, v92, v8, 0
    v_dot2_f32_bf16 v29, v93, v9, v29
    v_dot2_f32_bf16 v29, v94, v10, v29
    v_dot2_f32_bf16 v29, v95, v11, v29
    v_dot2_f32_bf16 v30, v96, v8, 0
    v_dot2_f32_bf16 v30, v97, v9, v30
    v_dot2_f32_bf16 v30, v98, v10, v30
    v_dot2_f32_bf16 v30, v99, v11, v30
    v_dot2_f32_bf16 v31, v100, v8, 0
    v_dot2_f32_bf16 v31, v101, v9, v31
    v_dot2_f32_bf16 v31, v102, v10, v31
    v_dot2_f32_bf16 v31, v103, v11, v31
    v_add_f32_dpp v24, v24, v24 row_ror:8 row_mask:0xf bank_mask:0x3
    v_add_f32_dpp v25, v25, v25 row_ror:8 row_mask:0xf bank_mask:0x3
    v_add_f32_dpp v26, v26, v26 row_ror:8 row_mask:0xf bank_mask:0x3
    v_add_f32_dpp v27, v27, v27 row_ror:8 row_mask:0xf bank_mask:0x3
    v_add_f32_dpp v24, v28, v28 row_ror:8 row_mask:0xf bank_mask:0xc
    v_add_f32_dpp v25, v29, v29 row_ror:8 row_mask:0xf bank_mask:0xc
    v_add_f32_dpp v26, v30, v30 row_ror:8 row_mask:0xf bank_mask:0xc
    v_add_f32_dpp v27, v31, v31 row_ror:8 row_mask:0xf bank_mask:0xc
    v_add_f32_dpp v24, v24, v24 row_half_mirror row_mask:0xf bank_mask:0x5
    v_add_f32_dpp v25, v25, v25 row_half_mirror row_mask:0xf bank_mask:0x5
    s_nop 0
    v_add_f32_dpp v24, v26, v26 row_half_mirror row_mask:0xf bank_mask:0xa
    v_add_f32_dpp v25, v27, v27 row_half_mirror row_mask:0xf bank_mask:0xa
    s_nop 0
    v_add_f32_dpp v24, v24, v24 quad_perm:[1,0,3,2] row_mask:0xf bank_mask:0xf
    v_add_f32_dpp v25, v25, v25 quad_perm:[1,0,3,2] row_mask:0xf bank_mask:0xf
    v_cndmask_b32 v24, v24, v25, s[72:73]
    s_nop 1
    v_add_f32_dpp v24, v24, v24 quad_perm:[2,3,0,1] row_mask:0xf bank_mask:0xf
    v_cvt_pk_bf16_f32 v34, v24, v24
    v_and_b32 v34, 0xffff0000, v34
    v_mul_f32 v34, s78, v34
    v_cvt_pk_bf16_f32 v34, v34, v34
    v_and_b32 v34, 0xffff0000, v34
    ds_write_b32 v113, v34 offset:8192
    v_max_f32 v32, v32, v34
    v_add_u32 v113, 128, v113
    s_sub_u32 s80, s80, 1
    s_cmp_eq_u32 s80, 0
    s_cbranch_scc1 L_loopK
    ds_read_b128 v[72:75], v105 offset:0
    ds_read_b128 v[76:79], v105 offset:1024
    ds_read_b128 v[80:83], v105 offset:2048
    ds_read_b128 v[84:87], v105 offset:3072
    ds_read_b128 v[88:91], v105 offset:4096
    ds_read_b128 v[92:95], v105 offset:5120
    ds_read_b128 v[96:99], v105 offset:6144
    ds_read_b128 v[100:103], v105 offset:7168
    v_add_u32 v105, 8192, v105
    s_branch L_loopK
L_midk:
    s_waitcnt vmcnt(5)
    v_dot2_f32_bf16 v24, v40, v8, 0
    v_dot2_f32_bf16 v24, v41, v9, v24
    v_dot2_f32_bf16 v24, v42, v10, v24
    v_dot2_f32_bf16 v24, v43, v11, v24
    buffer_load_dwordx4 v[40:43], v2, s[40:43], s12 offen offset:0 nt
    s_waitcnt vmcnt(5)
    v_dot2_f32_bf16 v25, v44, v8, 0
    v_dot2_f32_bf16 v25, v45, v9, v25
    v_dot2_f32_bf16 v25, v46, v10, v25
    v_dot2_f32_bf16 v25, v47, v11, v25
    buffer_load_dwordx4 v[44:47], v2, s[40:43], s12 offen offset:1024 nt
    s_waitcnt vmcnt(5)
    v_dot2_f32_bf16 v26, v48, v8, 0
    v_dot2_f32_bf16 v26, v49, v9, v26
    v_dot2_f32_bf16 v26, v50, v10, v26
    v_dot2_f32_bf16 v26, v51, v11, v26
    buffer_load_dwordx4 v[48:51], v2, s[40:43], s12 offen offset:2048 nt
    s_waitcnt vmcnt(5)
    v_dot2_f32_bf16 v27, v52, v8, 0
    v_dot2_f32_bf16 v27, v53, v9, v27
    v_dot2_f32_bf16 v27, v54, v10, v27
    v_dot2_f32_bf16 v27, v55, v11, v27
    buffer_load_dwordx4 v[52:55], v2, s[40:43], s12 offen offset:3072 nt
    s_waitcnt vmcnt(5)
    v_dot2_f32_bf16 v28, v56, v8, 0
    v_dot2_f32_bf16 v28, v57, v9, v28
    v_dot2_f32_bf16 v28, v58, v10, v28
    v_dot2_f32_bf16 v28, v59, v11, v28
    buffer_load_dwordx4 v[56:59], v3, s[40:43], s12 offen offset:0 nt
    s_waitcnt vmcnt(5)
    v_dot2_f32_bf16 v29, v60, v8, 0
    v_dot2_f32_bf16 v29, v61, v9, v29
    v_dot2_f32_bf16 v29, v62, v10, v29
    v_dot2_f32_bf16 v29, v63, v11, v29
    buffer_load_dwordx4 v[60:63], v3, s[40:43], s12 offen offset:1024 nt
    s_waitcnt vmcnt(5)
    v_dot2_f32_bf16 v30, v64, v8, 0
    v_dot2_f32_bf16 v30, v65, v9, v30
    v_dot2_f32_bf16 v30, v66, v10, v30
    v_dot2_f32_bf16 v30, v67, v11, v30
    buffer_load_dwordx4 v[64:67], v3, s[40:43], s12 offen offset:2048 nt
    s_waitcnt vmcnt(5)
    v_dot2_f32_bf16 v31, v68, v8, 0
    v_dot2_f32_bf16 v31, v69, v9, v31
    v_dot2_f32_bf16 v31, v70, v10, v31
    v_dot2_f32_bf16 v31, v71, v11, v31
    buffer_load_dwordx4 v[68:71], v3, s[40:43], s12 offen offset:3072 nt
    s_memrealtime s[62:63]
    v_add_f32_dpp v24, v24, v24 row_ror:8 row_mask:0xf bank_mask:0x3
    v_add_f32_dpp v25, v25, v25 row_ror:8 row_mask:0xf bank_mask:0x3
    v_add_f32_dpp v26, v26, v26 row_ror:8 row_mask:0xf bank_mask:0x3
    v_add_f32_dpp v27, v27, v27 row_ror:8 row_mask:0xf bank_mask:0x3
    v_add_f32_dpp v24, v28, v28 row_ror:8 row_mask:0xf bank_mask:0xc
    v_add_f32_dpp v25, v29, v29 row_ror:8 row_mask:0xf bank_mask:0xc
    v_add_f32_dpp v26, v30, v30 row_ror:8 row_mask:0xf bank_mask:0xc
    v_add_f32_dpp v27, v31, v31 row_ror:8 row_mask:0xf bank_mask:0xc
    v_add_f32_dpp v24, v24, v24 row_half_mirror row_mask:0xf bank_mask:0x5
    v_add_f32_dpp v25, v25, v25 row_half_mirror row_mask:0xf bank_mask:0x5
    s_nop 0
    v_add_f32_dpp v24, v26, v26 row_half_mirror row_mask:0xf bank_mask:0xa
    v_add_f32_dpp v25, v27, v27 row_half_mirror row_mask:0xf bank_mask:0xa
    s_nop 0
    v_add_f32_dpp v24, v24, v24 quad_perm:[1,0,3,2] row_mask:0xf bank_mask:0xf
    v_add_f32_dpp v25, v25, v25 quad_perm:[1,0,3,2] row_mask:0xf bank_mask:0xf
    v_cndmask_b32 v24, v24, v25, s[72:73]
    s_nop 1
    v_add_f32_dpp v24, v24, v24 quad_perm:[2,3,0,1] row_mask:0xf bank_mask:0xf
    v_cvt_pk_bf16_f32 v34, v24, v24
    v_and_b32 v34, 0xffff0000, v34
    v_mul_f32 v34, s78, v34
    v_cvt_pk_bf16_f32 v34, v34, v34
    v_and_b32 v34, 0xffff0000, v34
    ds_write_b32 v112, v34 offset:8192
    v_max_f32 v32, v32, v34
    s_branch L_joink
L_midv:
    v_sub_f32 v35, v115, v32
    ds_read_b32 v115, v114 offset:8192
    v_add_u32 v114, 128, v114
    v_mul_f32 v35, 0x3fb8aa3b, v35
    v_exp_f32 v35, v35
    s_nop 0
    v_cvt_pk_bf16_f32 v36, v35, v35
    v_add_f32 v33, v33, v35
    s_nop 0
    v_and_b32_dpp v16, v36, v4 row_newbcast:0 row_mask:0xf bank_mask:0xf
    v_and_b32_dpp v17, v36, v5 row_newbcast:0 row_mask:0xf bank_mask:0xf
    v_and_b32_dpp v18, v36, v6 row_newbcast:0 row_mask:0xf bank_mask:0xf
    v_and_b32_dpp v19, v36, v7 row_newbcast:0 row_mask:0xf bank_mask:0xf
    v_and_b32_dpp v20, v36, v4 row_newbcast:1 row_mask:0xf bank_mask:0xf
    v_and_b32_dpp v21, v36, v5 row_newbcast:1 row_mask:0xf bank_mask:0xf
    v_and_b32_dpp v22, v36, v6 row_newbcast:1 row_mask:0xf bank_mask:0xf
    v_and_b32_dpp v23, v36, v7 row_newbcast:1 row_mask:0xf bank_mask:0xf
    s_waitcnt vmcnt(5)
    v_mfma_f32_16x16x32_bf16 v[12:15], v[16:19], v[40:43], v[12:15]
    buffer_load_dwordx4 v[40:43], v2, s[40:43], s12 offen offset:0 nt
    v_and_b32_dpp v16, v36, v4 row_newbcast:4 row_mask:0xf bank_mask:0xf
    v_and_b32_dpp v17, v36, v5 row_newbcast:4 row_mask:0xf bank_mask:0xf
    v_and_b32_dpp v18, v36, v6 row_newbcast:4 row_mask:0xf bank_mask:0xf
    v_and_b32_dpp v19, v36, v7 row_newbcast:4 row_mask:0xf bank_mask:0xf
    s_waitcnt vmcnt(5)
    v_mfma_f32_16x16x32_bf16 v[12:15], v[20:23], v[44:47], v[12:15]
    buffer_load_dwordx4 v[44:47], v2, s[40:43], s12 offen offset:1024 nt
    v_and_b32_dpp v20, v36, v4 row_newbcast:5 row_mask:0xf bank_mask:0xf
    v_and_b32_dpp v21, v36, v5 row_newbcast:5 row_mask:0xf bank_mask:0xf
    v_and_b32_dpp v22, v36, v6 row_newbcast:5 row_mask:0xf bank_mask:0xf
    v_and_b32_dpp v23, v36, v7 row_newbcast:5 row_mask:0xf bank_mask:0xf
    s_waitcnt vmcnt(5)
    v_mfma_f32_16x16x32_bf16 v[12:15], v[16:19], v[48:51], v[12:15]
    buffer_load_dwordx4 v[48:51], v2, s[40:43], s12 offen offset:2048 nt
    v_and_b32_dpp v16, v36, v4 row_newbcast:8 row_mask:0xf bank_mask:0xf
    v_and_b32_dpp v17, v36, v5 row_newbcast:8 row_mask:0xf bank_mask:0xf
    v_and_b32_dpp v18, v36, v6 row_newbcast:8 row_mask:0xf bank_mask:0xf
    v_and_b32_dpp v19, v36, v7 row_newbcast:8 row_mask:0xf bank_mask:0xf
    s_waitcnt vmcnt(5)
    v_mfma_f32_16x16x32_bf16 v[12:15], v[20:23], v[52:55], v[12:15]
    buffer_load_dwordx4 v[52:55], v2, s[40:43], s12 offen offset:3072 nt
    v_and_b32_dpp v20, v36, v4 row_newbcast:9 row_mask:0xf bank_mask:0xf
    v_and_b32_dpp v21, v36, v5 row_newbcast:9 row_mask:0xf bank_mask:0xf
    v_and_b32_dpp v22, v36, v6 row_newbcast:9 row_mask:0xf bank_mask:0xf
    v_and_b32_dpp v23, v36, v7 row_newbcast:9 row_mask:0xf bank_mask:0xf
    s_waitcnt vmcnt(5)
    v_mfma_f32_16x16x32_bf16 v[12:15], v[16:19], v[56:59], v[12:15]
    buffer_load_dwordx4 v[56:59], v3, s[40:43], s12 offen offset:0 nt
    v_and_b32_dpp v16, v36, v4 row_newbcast:12 row_mask:0xf bank_mask:0xf
    v_and_b32_dpp v17, v36, v5 row_newbcast:12 row_mask:0xf bank_mask:0xf
    v_and_b32_dpp v18, v36, v6 row_newbcast:12 row_mask:0xf bank_mask:0xf
    v_and_b32_dpp v19, v36, v7 row_newbcast:12 row_mask:0xf bank_mask:0xf
    s_waitcnt vmcnt(5)
    v_mfma_f32_16x16x32_bf16 v[12:15], v[20:23], v[60:63], v[12:15]
    buffer_load_dwordx4 v[60:63], v3, s[40:43], s12 offen offset:1024 nt
    v_and_b32_dpp v20, v36, v4 row_newbcast:13 row_mask:0xf bank_mask:0xf
    v_and_b32_dpp v21, v36, v5 row_newbcast:13 row_mask:0xf bank_mask:0xf
    v_and_b32_dpp v22, v36, v6 row_newbcast:13 row_mask:0xf bank_mask:0xf
    v_and_b32_dpp v23, v36, v7 row_newbcast:13 row_mask:0xf bank_mask:0xf
    s_waitcnt vmcnt(5)
    v_mfma_f32_16x16x32_bf16 v[12:15], v[16:19], v[64:67], v[12:15]
    buffer_load_dwordx4 v[64:67], v3, s[40:43], s12 offen offset:2048 nt
    s_waitcnt vmcnt(5)
    v_mfma_f32_16x16x32_bf16 v[12:15], v[20:23], v[68:71], v[12:15]
    s_memrealtime s[62:63]
    buffer_load_dwordx4 v[68:71], v3, s[40:43], s12 offen offset:3072 nt
    s_branch L_joinv
L_widek:
    s_cmp_lt_u32 s8, 60
    s_cbranch_scc1 L_midk
    s_waitcnt vmcnt(7)
    v_dot2_f32_bf16 v24, v40, v8, 0
    v_dot2_f32_bf16 v24, v41, v9, v24
    v_dot2_f32_bf16 v24, v42, v10, v24
    v_dot2_f32_bf16 v24, v43, v11, v24
    buffer_load_dwordx4 v[40:43], v2, s[40:43], s12 offen offset:0 nt
    s_waitcnt vmcnt(7)
    v_dot2_f32_bf16 v25, v44, v8, 0
    v_dot2_f32_bf16 v25, v45, v9, v25
    v_dot2_f32_bf16 v25, v46, v10, v25
    v_dot2_f32_bf16 v25, v47, v11, v25
    buffer_load_dwordx4 v[44:47], v2, s[40:43], s12 offen offset:1024 nt
    s_waitcnt vmcnt(7)
    v_dot2_f32_bf16 v26, v48, v8, 0
    v_dot2_f32_bf16 v26, v49, v9, v26
    v_dot2_f32_bf16 v26, v50, v10, v26
    v_dot2_f32_bf16 v26, v51, v11, v26
    buffer_load_dwordx4 v[48:51], v2, s[40:43], s12 offen offset:2048 nt
    s_waitcnt vmcnt(7)
    v_dot2_f32_bf16 v27, v52, v8, 0
    v_dot2_f32_bf16 v27, v53, v9, v27
    v_dot2_f32_bf16 v27, v54, v10, v27
    v_dot2_f32_bf16 v27, v55, v11, v27
    buffer_load_dwordx4 v[52:55], v2, s[40:43], s12 offen offset:3072 nt
    s_waitcnt vmcnt(7)
    v_dot2_f32_bf16 v28, v56, v8, 0
    v_dot2_f32_bf16 v28, v57, v9, v28
    v_dot2_f32_bf16 v28, v58, v10, v28
    v_dot2_f32_bf16 v28, v59, v11, v28
    buffer_load_dwordx4 v[56:59], v3, s[40:43], s12 offen offset:0 nt
    s_waitcnt vmcnt(7)
    v_dot2_f32_bf16 v29, v60, v8, 0
    v_dot2_f32_bf16 v29, v61, v9, v29
    v_dot2_f32_bf16 v29, v62, v10, v29
    v_dot2_f32_bf16 v29, v63, v11, v29
    buffer_load_dwordx4 v[60:63], v3, s[40:43], s12 offen offset:1024 nt
    s_waitcnt vmcnt(7)
    v_dot2_f32_bf16 v30, v64, v8, 0
    v_dot2_f32_bf16 v30, v65, v9, v30
    v_dot2_f32_bf16 v30, v66, v10, v30
    v_dot2_f32_bf16 v30, v67, v11, v30
    buffer_load_dwordx4 v[64:67], v3, s[40:43], s12 offen offset:2048 nt
    s_waitcnt vmcnt(7)
    v_dot2_f32_bf16 v31, v68, v8, 0
    v_dot2_f32_bf16 v31, v69, v9, v31
    v_dot2_f32_bf16 v31, v70, v10, v31
    v_dot2_f32_bf16 v31, v71, v11, v31
    buffer_load_dwordx4 v[68:71], v3, s[40:43], s12 offen offset:3072 nt
    s_memrealtime s[62:63]
    v_add_f32_dpp v24, v24, v24 row_ror:8 row_mask:0xf bank_mask:0x3
    v_add_f32_dpp v25, v25, v25 row_ror:8 row_mask:0xf bank_mask:0x3
    v_add_f32_dpp v26, v26, v26 row_ror:8 row_mask:0xf bank_mask:0x3
    v_add_f32_dpp v27, v27, v27 row_ror:8 row_mask:0xf bank_mask:0x3
    v_add_f32_dpp v24, v28, v28 row_ror:8 row_mask:0xf bank_mask:0xc
    v_add_f32_dpp v25, v29, v29 row_ror:8 row_mask:0xf bank_mask:0xc
    v_add_f32_dpp v26, v30, v30 row_ror:8 row_mask:0xf bank_mask:0xc
    v_add_f32_dpp v27, v31, v31 row_ror:8 row_mask:0xf bank_mask:0xc
    v_add_f32_dpp v24, v24, v24 row_half_mirror row_mask:0xf bank_mask:0x5
    v_add_f32_dpp v25, v25, v25 row_half_mirror row_mask:0xf bank_mask:0x5
    s_nop 0
    v_add_f32_dpp v24, v26, v26 row_half_mirror row_mask:0xf bank_mask:0xa
    v_add_f32_dpp v25, v27, v27 row_half_mirror row_mask:0xf bank_mask:0xa
    s_nop 0
    v_add_f32_dpp v24, v24, v24 quad_perm:[1,0,3,2] row_mask:0xf bank_mask:0xf
    v_add_f32_dpp v25, v25, v25 quad_perm:[1,0,3,2] row_mask:0xf bank_mask:0xf
    v_cndmask_b32 v24, v24, v25, s[72:73]
    s_nop 1
    v_add_f32_dpp v24, v24, v24 quad_perm:[2,3,0,1] row_mask:0xf bank_mask:0xf
    v_cvt_pk_bf16_f32 v34, v24, v24
    v_and_b32 v34, 0xffff0000, v34
    v_mul_f32 v34, s78, v34
    v_cvt_pk_bf16_f32 v34, v34, v34
    v_and_b32 v34, 0xffff0000, v34
    ds_write_b32 v112, v34 offset:8192
    v_max_f32 v32, v32, v34
    s_branch L_joink
L_slowk:
    s_waitcnt vmcnt(3)
    v_dot2_f32_bf16 v24, v40, v8, 0
    v_dot2_f32_bf16 v24, v41, v9, v24
    v_dot2_f32_bf16 v24, v42, v10, v24
    v_dot2_f32_bf16 v24, v43, v11, v24
    buffer_load_dwordx4 v[40:43], v2, s[40:43], s12 offen offset:0 nt
    s_waitcnt vmcnt(3)
    v_dot2_f32_bf16 v25, v44, v8, 0
    v_dot2_f32_bf16 v25, v45, v9, v25
    v_dot2_f32_bf16 v25, v46, v10, v25
    v_dot2_f32_bf16 v25, v47, v11, v25
    buffer_load_dwordx4 v[44:47], v2, s[40:43], s12 offen offset:1024 nt
    s_waitcnt vmcnt(3)
    v_dot2_f32_bf16 v26, v48, v8, 0
    v_dot2_f32_bf16 v26, v49, v9, v26
    v_dot2_f32_bf16 v26, v50, v10, v26
    v_dot2_f32_bf16 v26, v51, v11, v26
    buffer_load_dwordx4 v[48:51], v2, s[40:43], s12 offen offset:2048 nt
    s_waitcnt vmcnt(3)
    v_dot2_f32_bf16 v27, v52, v8, 0
    v_dot2_f32_bf16 v27, v53, v9, v27
    v_dot2_f32_bf16 v27, v54, v10, v27
    v_dot2_f32_bf16 v27, v55, v11, v27
    buffer_load_dwordx4 v[52:55], v2, s[40:43], s12 offen offset:3072 nt
    s_waitcnt vmcnt(3)
    v_dot2_f32_bf16 v28, v56, v8, 0
    v_dot2_f32_bf16 v28, v57, v9, v28
    v_dot2_f32_bf16 v28, v58, v10, v28
    v_dot2_f32_bf16 v28, v59, v11, v28
    buffer_load_dwordx4 v[56:59], v3, s[40:43], s12 offen offset:0 nt
    s_waitcnt vmcnt(3)
    v_dot2_f32_bf16 v29, v60, v8, 0
    v_dot2_f32_bf16 v29, v61, v9, v29
    v_dot2_f32_bf16 v29, v62, v10, v29
    v_dot2_f32_bf16 v29, v63, v11, v29
    buffer_load_dwordx4 v[60:63], v3, s[40:43], s12 offen offset:1024 nt
    s_waitcnt vmcnt(3)
    v_dot2_f32_bf16 v30, v64, v8, 0
    v_dot2_f32_bf16 v30, v65, v9, v30
    v_dot2_f32_bf16 v30, v66, v10, v30
    v_dot2_f32_bf16 v30, v67, v11, v30
    buffer_load_dwordx4 v[64:67], v3, s[40:43], s12 offen offset:2048 nt
    s_waitcnt vmcnt(3)
    v_dot2_f32_bf16 v31, v68, v8, 0
    v_dot2_f32_bf16 v31, v69, v9, v31
    v_dot2_f32_bf16 v31, v70, v10, v31
    v_dot2_f32_bf16 v31, v71, v11, v31
    buffer_load_dwordx4 v[68:71], v3, s[40:43], s12 offen offset:3072 nt
    s_memrealtime s[62:63]
    v_add_f32_dpp v24, v24, v24 row_ror:8 row_mask:0xf bank_mask:0x3
    v_add_f32_dpp v25, v25, v25 row_ror:8 row_mask:0xf bank_mask:0x3
    v_add_f32_dpp v26, v26, v26 row_ror:8 row_mask:0xf bank_mask:0x3
    v_add_f32_dpp v27, v27, v27 row_ror:8 row_mask:0xf bank_mask:0x3
    v_add_f32_dpp v24, v28, v28 row_ror:8 row_mask:0xf bank_mask:0xc
    v_add_f32_dpp v25, v29, v29 row_ror:8 row_mask:0xf bank_mask:0xc
    v_add_f32_dpp v26, v30, v30 row_ror:8 row_mask:0xf bank_mask:0xc
    v_add_f32_dpp v27, v31, v31 row_ror:8 row_mask:0xf bank_mask:0xc
    v_add_f32_dpp v24, v24, v24 row_half_mirror row_mask:0xf bank_mask:0x5
    v_add_f32_dpp v25, v25, v25 row_half_mirror row_mask:0xf bank_mask:0x5
    s_nop 0
    v_add_f32_dpp v24, v26, v26 row_half_mirror row_mask:0xf bank_mask:0xa
    v_add_f32_dpp v25, v27, v27 row_half_mirror row_mask:0xf bank_mask:0xa
    s_nop 0
    v_add_f32_dpp v24, v24, v24 quad_perm:[1,0,3,2] row_mask:0xf bank_mask:0xf
    v_add_f32_dpp v25, v25, v25 quad_perm:[1,0,3,2] row_mask:0xf bank_mask:0xf
    v_cndmask_b32 v24, v24, v25, s[72:73]
    s_nop 1
    v_add_f32_dpp v24, v24, v24 quad_perm:[2,3,0,1] row_mask:0xf bank_mask:0xf
    v_cvt_pk_bf16_f32 v34, v24, v24
    v_and_b32 v34, 0xffff0000, v34
    v_mul_f32 v34, s78, v34
    v_cvt_pk_bf16_f32 v34, v34, v34
    v_and_b32 v34, 0xffff0000, v34
    ds_write_b32 v112, v34 offset:8192
    v_max_f32 v32, v32, v34
    s_branch L_joink
L_widev:
    s_cmp_lt_u32 s8, 60
    s_cbranch_scc1 L_midv
    v_sub_f32 v35, v115, v32
    ds_read_b32 v115, v114 offset:8192
    v_add_u32 v114, 128, v114
    v_mul_f32 v35, 0x3fb8aa3b, v35
    v_exp_f32 v35, v35
    s_nop 0
    v_cvt_pk_bf16_f32 v36, v35, v35
    v_add_f32 v33, v33, v35
    s_nop 0
    v_and_b32_dpp v16, v36, v4 row_newbcast:0 row_mask:0xf bank_mask:0xf
    v_and_b32_dpp v17, v36, v5 row_newbcast:0 row_mask:0xf bank_mask:0xf
    v_and_b32_dpp v18, v36, v6 row_newbcast:0 row_mask:0xf bank_mask:0xf
    v_and_b32_dpp v19, v36, v7 row_newbcast:0 row_mask:0xf bank_mask:0xf
    v_and_b32_dpp v20, v36, v4 row_newbcast:1 row_mask:0xf bank_mask:0xf
    v_and_b32_dpp v21, v36, v5 row_newbcast:1 row_mask:0xf bank_mask:0xf
    v_and_b32_dpp v22, v36, v6 row_newbcast:1 row_mask:0xf bank_mask:0xf
    v_and_b32_dpp v23, v36, v7 row_newbcast:1 row_mask:0xf bank_mask:0xf
    s_waitcnt vmcnt(7)
    v_mfma_f32_16x16x32_bf16 v[12:15], v[16:19], v[40:43], v[12:15]
    buffer_load_dwordx4 v[40:43], v2, s[40:43], s12 offen offset:0 nt
    v_and_b32_dpp v16, v36, v4 row_newbcast:4 row_mask:0xf bank_mask:0xf
    v_and_b32_dpp v17, v36, v5 row_newbcast:4 row_mask:0xf bank_mask:0xf
    v_and_b32_dpp v18, v36, v6 row_newbcast:4 row_mask:0xf bank_mask:0xf
    v_and_b32_dpp v19, v36, v7 row_newbcast:4 row_mask:0xf bank_mask:0xf
    s_waitcnt vmcnt(7)
    v_mfma_f32_16x16x32_bf16 v[12:15], v[20:23], v[44:47], v[12:15]
    buffer_load_dwordx4 v[44:47], v2, s[40:43], s12 offen offset:1024 nt
    v_and_b32_dpp v20, v36, v4 row_newbcast:5 row_mask:0xf bank_mask:0xf
    v_and_b32_dpp v21, v36, v5 row_newbcast:5 row_mask:0xf bank_mask:0xf
    v_and_b32_dpp v22, v36, v6 row_newbcast:5 row_mask:0xf bank_mask:0xf
    v_and_b32_dpp v23, v36, v7 row_newbcast:5 row_mask:0xf bank_mask:0xf
    s_waitcnt vmcnt(7)
    v_mfma_f32_16x16x32_bf16 v[12:15], v[16:19], v[48:51], v[12:15]
    buffer_load_dwordx4 v[48:51], v2, s[40:43], s12 offen offset:2048 nt
    v_and_b32_dpp v16, v36, v4 row_newbcast:8 row_mask:0xf bank_mask:0xf
    v_and_b32_dpp v17, v36, v5 row_newbcast:8 row_mask:0xf bank_mask:0xf
    v_and_b32_dpp v18, v36, v6 row_newbcast:8 row_mask:0xf bank_mask:0xf
    v_and_b32_dpp v19, v36, v7 row_newbcast:8 row_mask:0xf bank_mask:0xf
    s_waitcnt vmcnt(7)
    v_mfma_f32_16x16x32_bf16 v[12:15], v[20:23], v[52:55], v[12:15]
    buffer_load_dwordx4 v[52:55], v2, s[40:43], s12 offen offset:3072 nt
    v_and_b32_dpp v20, v36, v4 row_newbcast:9 row_mask:0xf bank_mask:0xf
    v_and_b32_dpp v21, v36, v5 row_newbcast:9 row_mask:0xf bank_mask:0xf
    v_and_b32_dpp v22, v36, v6 row_newbcast:9 row_mask:0xf bank_mask:0xf
    v_and_b32_dpp v23, v36, v7 row_newbcast:9 row_mask:0xf bank_mask:0xf
    s_waitcnt vmcnt(7)
    v_mfma_f32_16x16x32_bf16 v[12:15], v[16:19], v[56:59], v[12:15]
    buffer_load_dwordx4 v[56:59], v3, s[40:43], s12 offen offset:0 nt
    v_and_b32_dpp v16, v36, v4 row_newbcast:12 row_mask:0xf bank_mask:0xf
    v_and_b32_dpp v17, v36, v5 row_newbcast:12 row_mask:0xf bank_mask:0xf
    v_and_b32_dpp v18, v36, v6 row_newbcast:12 row_mask:0xf bank_mask:0xf
    v_and_b32_dpp v19, v36, v7 row_newbcast:12 row_mask:0xf bank_mask:0xf
    s_waitcnt vmcnt(7)
    v_mfma_f32_16x16x32_bf16 v[12:15], v[20:23], v[60:63], v[12:15]
    buffer_load_dwordx4 v[60:63], v3, s[40:43], s12 offen offset:1024 nt
    v_and_b32_dpp v20, v36, v4 row_newbcast:13 row_mask:0xf bank_mask:0xf
    v_and_b32_dpp v21, v36, v5 row_newbcast:13 row_mask:0xf bank_mask:0xf
    v_and_b32_dpp v22, v36, v6 row_newbcast:13 row_mask:0xf bank_mask:0xf
    v_and_b32_dpp v23, v36, v7 row_newbcast:13 row_mask:0xf bank_mask:0xf
    s_waitcnt vmcnt(7)
    v_mfma_f32_16x16x32_bf16 v[12:15], v[16:19], v[64:67], v[12:15]
    buffer_load_dwordx4 v[64:67], v3, s[40:43], s12 offen offset:2048 nt
    s_waitcnt vmcnt(7)
    v_mfma_f32_16x16x32_bf16 v[12:15], v[20:23], v[68:71], v[12:15]
    s_memrealtime s[62:63]
    buffer_load_dwordx4 v[68:71], v3, s[40:43], s12 offen offset:3072 nt
    s_branch L_joinv
L_slowv:
    v_sub_f32 v35, v115, v32
    ds_read_b32 v115, v114 offset:8192
    v_add_u32 v114, 128, v114
    v_mul_f32 v35, 0x3fb8aa3b, v35
    v_exp_f32 v35, v35
    s_nop 0
    v_cvt_pk_bf16_f32 v36, v35, v35
    v_add_f32 v33, v33, v35
    s_nop 0
    v_and_b32_dpp v16, v36, v4 row_newbcast:0 row_mask:0xf bank_mask:0xf
    v_and_b32_dpp v17, v36, v5 row_newbcast:0 row_mask:0xf bank_mask:0xf
    v_and_b32_dpp v18, v36, v6 row_newbcast:0 row_mask:0xf bank_mask:0xf
    v_and_b32_dpp v19, v36, v7 row_newbcast:0 row_mask:0xf bank_mask:0xf
    v_and_b32_dpp v20, v36, v4 row_newbcast:1 row_mask:0xf bank_mask:0xf
    v_and_b32_dpp v21, v36, v5 row_newbcast:1 row_mask:0xf bank_mask:0xf
    v_and_b32_dpp v22, v36, v6 row_newbcast:1 row_mask:0xf bank_mask:0xf
    v_and_b32_dpp v23, v36, v7 row_newbcast:1 row_mask:0xf bank_mask:0xf
    s_waitcnt vmcnt(3)
    v_mfma_f32_16x16x32_bf16 v[12:15], v[16:19], v[40:43], v[12:15]
    buffer_load_dwordx4 v[40:43], v2, s[40:43], s12 offen offset:0 nt
    v_and_b32_dpp v16, v36, v4 row_newbcast:4 row_mask:0xf bank_mask:0xf
    v_and_b32_dpp v17, v36, v5 row_newbcast:4 row_mask:0xf bank_mask:0xf
    v_and_b32_dpp v18, v36, v6 row_newbcast:4 row_mask:0xf bank_mask:0xf
    v_and_b32_dpp v19, v36, v7 row_newbcast:4 row_mask:0xf bank_mask:0xf
    s_waitcnt vmcnt(3)
    v_mfma_f32_16x16x32_bf16 v[12:15], v[20:23], v[44:47], v[12:15]
    buffer_load_dwordx4 v[44:47], v2, s[40:43], s12 offen offset:1024 nt
    v_and_b32_dpp v20, v36, v4 row_newbcast:5 row_mask:0xf bank_mask:0xf
    v_and_b32_dpp v21, v36, v5 row_newbcast:5 row_mask:0xf bank_mask:0xf
    v_and_b32_dpp v22, v36, v6 row_newbcast:5 row_mask:0xf bank_mask:0xf
    v_and_b32_dpp v23, v36, v7 row_newbcast:5 row_mask:0xf bank_mask:0xf
    s_waitcnt vmcnt(3)
    v_mfma_f32_16x16x32_bf16 v[12:15], v[16:19], v[48:51], v[12:15]
    buffer_load_dwordx4 v[48:51], v2, s[40:43], s12 offen offset:2048 nt
    v_and_b32_dpp v16, v36, v4 row_newbcast:8 row_mask:0xf bank_mask:0xf
    v_and_b32_dpp v17, v36, v5 row_newbcast:8 row_mask:0xf bank_mask:0xf
    v_and_b32_dpp v18, v36, v6 row_newbcast:8 row_mask:0xf bank_mask:0xf
    v_and_b32_dpp v19, v36, v7 row_newbcast:8 row_mask:0xf bank_mask:0xf
    s_waitcnt vmcnt(3)
    v_mfma_f32_16x16x32_bf16 v[12:15], v[20:23], v[52:55], v[12:15]
    buffer_load_dwordx4 v[52:55], v2, s[40:43], s12 offen offset:3072 nt
    v_and_b32_dpp v20, v36, v4 row_newbcast:9 row_mask:0xf bank_mask:0xf
    v_and_b32_dpp v21, v36, v5 row_newbcast:9 row_mask:0xf bank_mask:0xf
    v_and_b32_dpp v22, v36, v6 row_newbcast:9 row_mask:0xf bank_mask:0xf
    v_and_b32_dpp v23, v36, v7 row_newbcast:9 row_mask:0xf bank_mask:0xf
    s_waitcnt vmcnt(3)
    v_mfma_f32_16x16x32_bf16 v[12:15], v[16:19], v[56:59], v[12:15]
    buffer_load_dwordx4 v[56:59], v3, s[40:43], s12 offen offset:0 nt
    v_and_b32_dpp v16, v36, v4 row_newbcast:12 row_mask:0xf bank_mask:0xf
    v_and_b32_dpp v17, v36, v5 row_newbcast:12 row_mask:0xf bank_mask:0xf
    v_and_b32_dpp v18, v36, v6 row_newbcast:12 row_mask:0xf bank_mask:0xf
    v_and_b32_dpp v19, v36, v7 row_newbcast:12 row_mask:0xf bank_mask:0xf
    s_waitcnt vmcnt(3)
    v_mfma_f32_16x16x32_bf16 v[12:15], v[20:23], v[60:63], v[12:15]
    buffer_load_dwordx4 v[60:63], v3, s[40:43], s12 offen offset:1024 nt
    v_and_b32_dpp v20, v36, v4 row_newbcast:13 row_mask:0xf bank_mask:0xf
    v_and_b32_dpp v21, v36, v5 row_newbcast:13 row_mask:0xf bank_mask:0xf
    v_and_b32_dpp v22, v36, v6 row_newbcast:13 row_mask:0xf bank_mask:0xf
    v_and_b32_dpp v23, v36, v7 row_newbcast:13 row_mask:0xf bank_mask:0xf
    s_waitcnt vmcnt(3)
    v_mfma_f32_16x16x32_bf16 v[12:15], v[16:19], v[64:67], v[12:15]
    buffer_load_dwordx4 v[64:67], v3, s[40:43], s12 offen offset:2048 nt
    s_waitcnt vmcnt(3)
    v_mfma_f32_16x16x32_bf16 v[12:15], v[20:23], v[68:71], v[12:15]
    s_memrealtime s[62:63]
    buffer_load_dwordx4 v[68:71], v3, s[40:43], s12 offen offset:3072 nt
    s_branch L_joinv
L_helper:
    v_and_b32 v38, 15, v1
    v_lshrrev_b32 v39, 4, v1
    s_add_u32 s6, s4, s3
    s_and_b32 s6, s6, 7
    s_sub_u32 s8, 7, s6
    s_lshl_b32 s8, s8, 5
    s_add_u32 s8, s8, s3
    s_mul_i32 s70, s8, 205
    s_lshr_b32 s70, s70, 10
    s_mul_i32 s71, s70, 5
    s_sub_u32 s71, s8, s71
    s_add_u32 s70, s70, 32
    s_cmp_lt_u32 s8, 70
    s_cselect_b32 s70, s70, 63
    s_cmp_lt_u32 s6, 5
    s_cselect_b32 s70, s3, s70
    s_cselect_b32 s71, s6, s71
    v_lshlrev_b32 v2, 3, v1
    v_mov_b32 v8, 0
    v_mov_b32 v11, -1
    s_lshl_b32 s79, s3, 12
    s_add_u32 s79, s79, 65536
    s_lshl_b32 s8, s4, 8
    v_add_u32 v9, s8, v3
    s_lshl_b32 s8, s4, 3
    v_mov_b32 v12, s8
    s_mov_b32 s15, 0
    s_lshl_b32 s7, s4, 2
    v_add_u32 v34, s7, v38
    v_and_b32 v34, 31, v34
    v_xor_b32 v35, 16, v34
    v_lshlrev_b32 v36, 1, v39
    v_mad_u32_u24 v50, v34, 40, v36
    v_mad_u32_u24 v51, v35, 40, v36
    v_lshlrev_b32 v52, 13, v39
    v_lshl_add_u32 v52, v38, 4, v52
    s_mul_i32 s7, s4, 655360
    s_lshl_b32 s10, s3, 8
    s_add_u32 s7, s7, s10
    s_waitcnt lgkmcnt(0)
    s_load_dword s72, s[38:39], 720900
    s_mov_b32 s48, s16
    s_mov_b32 s49, s17
    s_mov_b32 s50, 1280
    s_mov_b32 s51, 0x20000
    s_mov_b32 s52, s22
    s_mov_b32 s53, s23
    s_mov_b32 s54, 5242880
    s_mov_b32 s55, 0x20000
    s_mov_b32 s56, s38
    s_mov_b32 s57, s39
    s_mov_b32 s58, 1310720
    s_mov_b32 s59, 0x20000
    s_barrier
    buffer_load_ushort v40, v50, s[48:51], 0 offen offset:0
    buffer_load_ushort v41, v50, s[48:51], 0 offen offset:8
    buffer_load_ushort v42, v50, s[48:51], 0 offen offset:16
    buffer_load_ushort v43, v50, s[48:51], 0 offen offset:24
    buffer_load_ushort v44, v50, s[48:51], 0 offen offset:32
    buffer_load_ushort v45, v51, s[48:51], 0 offen offset:0
    buffer_load_ushort v46, v51, s[48:51], 0 offen offset:8
    buffer_load_ushort v47, v51, s[48:51], 0 offen offset:16
    buffer_load_ushort v48, v51, s[48:51], 0 offen offset:24
    buffer_load_ushort v49, v51, s[48:51], 0 offen offset:32
    buffer_load_dwordx4 v[72:75], v52, s[52:55], s7 offen nt
    s_add_u32 s7, s7, 0x8000
    buffer_load_dwordx4 v[76:79], v52, s[52:55], s7 offen nt
    s_add_u32 s7, s7, 0x8000
    buffer_load_dwordx4 v[80:83], v52, s[52:55], s7 offen nt
    s_add_u32 s7, s7, 0x8000
    buffer_load_dwordx4 v[84:87], v52, s[52:55], s7 offen nt
    s_add_u32 s7, s7, 0x8000
    buffer_load_dwordx4 v[88:91], v52, s[52:55], s7 offen nt
    s_add_u32 s7, s7, 0x8000
    buffer_load_dwordx4 v[92:95], v52, s[52:55], s7 offen nt
    s_add_u32 s7, s7, 0x8000
    buffer_load_dwordx4 v[96:99], v52, s[52:55], s7 offen nt
    s_add_u32 s7, s7, 0x8000
    buffer_load_dwordx4 v[100:103], v52, s[52:55], s7 offen nt
    s_add_u32 s7, s7, 0x8000
    buffer_load_dwordx4 v[104:107], v52, s[52:55], s7 offen nt
    s_add_u32 s7, s7, 0x8000
    buffer_load_dwordx4 v[108:111], v52, s[52:55], s7 offen nt
    s_add_u32 s7, s7, 0x8000
    buffer_load_dwordx4 v[112:115], v52, s[52:55], s7 offen nt
    s_add_u32 s7, s7, 0x8000
    buffer_load_dwordx4 v[116:119], v52, s[52:55], s7 offen nt
    s_add_u32 s7, s7, 0x8000
    buffer_load_dwordx4 v[120:123], v52, s[52:55], s7 offen nt
    s_add_u32 s7, s7, 0x8000
    buffer_load_dwordx4 v[124:127], v52, s[52:55], s7 offen nt
    s_add_u32 s7, s7, 0x8000
    buffer_load_dwordx4 v[128:131], v52, s[52:55], s7 offen nt
    s_add_u32 s7, s7, 0x8000
    buffer_load_dwordx4 v[132:135], v52, s[52:55], s7 offen nt
    s_add_u32 s7, s7, 0x8000
    buffer_load_dwordx4 v[136:139], v52, s[52:55], s7 offen nt
    s_add_u32 s7, s7, 0x8000
    buffer_load_dwordx4 v[140:143], v52, s[52:55], s7 offen nt
    s_add_u32 s7, s7, 0x8000
    buffer_load_dwordx4 v[144:147], v52, s[52:55], s7 offen nt
    s_add_u32 s7, s7, 0x8000
    buffer_load_dwordx4 v[148:151], v52, s[52:55], s7 offen nt
    s_mov_b32 s40, s28
    s_mov_b32 s41, s29
    s_mov_b32 s42, 2211840
    s_mov_b32 s43, 0x20000
    s_mov_b32 s44, s30
    s_mov_b32 s45, s31
    s_mov_b32 s46, 2211840
    s_mov_b32 s47, 0x20000
    s_cmp_lt_u32 s3, 27
    s_cselect_b32 s42, s42, 0
    s_cselect_b32 s46, s46, 0
    v_mul_u32_u24 v66, 3456, v39
    v_and_b32 v35, 7, v38
    v_lshl_add_u32 v66, v35, 4, v66
    s_mul_i32 s7, s4, 276480
    s_lshl_b32 s8, s3, 7
    s_add_u32 s7, s7, s8
    s_mov_b32 s68, 0x00ff00ff
    s_mov_b32 s69, 0x00ff00ff
    s_mov_b64 exec, s[68:69]
    buffer_load_dwordx4 v[152:155], v66, s[40:43], s7 offen nt
    s_not_b64 exec, exec
    buffer_load_dwordx4 v[152:155], v66, s[44:47], s7 offen nt
    s_add_u32 s7, s7, 13824
    s_mov_b64 exec, s[68:69]
    buffer_load_dwordx4 v[156:159], v66, s[40:43], s7 offen nt
    s_not_b64 exec, exec
    buffer_load_dwordx4 v[156:159], v66, s[44:47], s7 offen nt
    s_add_u32 s7, s7, 13824
    s_mov_b64 exec, s[68:69]
    buffer_load_dwordx4 v[160:163], v66, s[40:43], s7 offen nt
    s_not_b64 exec, exec
    buffer_load_dwordx4 v[160:163], v66, s[44:47], s7 offen nt
    s_add_u32 s7, s7, 13824
    s_mov_b64 exec, s[68:69]
    buffer_load_dwordx4 v[164:167], v66, s[40:43], s7 offen nt
    s_not_b64 exec, exec
    buffer_load_dwordx4 v[164:167], v66, s[44:47], s7 offen nt
    s_add_u32 s7, s7, 13824
    s_mov_b64 exec, s[68:69]
    buffer_load_dwordx4 v[168:171], v66, s[40:43], s7 offen nt
    s_not_b64 exec, exec
    buffer_load_dwordx4 v[168:171], v66, s[44:47], s7 offen nt
    s_add_u32 s7, s7, 13824
    s_mov_b64 exec, s[68:69]
    buffer_load_dwordx4 v[172:175], v66, s[40:43], s7 offen nt
    s_not_b64 exec, exec
    buffer_load_dwordx4 v[172:175], v66, s[44:47], s7 offen nt
    s_add_u32 s7, s7, 13824
    s_mov_b64 exec, s[68:69]
    buffer_load_dwordx4 v[176:179], v66, s[40:43], s7 offen nt
    s_not_b64 exec, exec
    buffer_load_dwordx4 v[176:179], v66, s[44:47], s7 offen nt
    s_add_u32 s7, s7, 13824
    s_mov_b64 exec, s[68:69]
    buffer_load_dwordx4 v[180:183], v66, s[40:43], s7 offen nt
    s_not_b64 exec, exec
    buffer_load_dwordx4 v[180:183], v66, s[44:47], s7 offen nt
    s_add_u32 s7, s7, 13824
    s_mov_b64 exec, s[68:69]
    buffer_load_dwordx4 v[184:187], v66, s[40:43], s7 offen nt
    s_not_b64 exec, exec
    buffer_load_dwordx4 v[184:187], v66, s[44:47], s7 offen nt
    s_add_u32 s7, s7, 13824
    s_mov_b64 exec, s[68:69]
    buffer_load_dwordx4 v[188:191], v66, s[40:43], s7 offen nt
    s_not_b64 exec, exec
    buffer_load_dwordx4 v[188:191], v66, s[44:47], s7 offen nt
    s_add_u32 s7, s7, 13824
    s_mov_b64 exec, s[68:69]
    buffer_load_dwordx4 v[192:195], v66, s[40:43], s7 offen nt
    s_not_b64 exec, exec
    buffer_load_dwordx4 v[192:195], v66, s[44:47], s7 offen nt
    s_add_u32 s7, s7, 13824
    s_mov_b64 exec, s[68:69]
    buffer_load_dwordx4 v[196:199], v66, s[40:43], s7 offen nt
    s_not_b64 exec, exec
    buffer_load_dwordx4 v[196:199], v66, s[44:47], s7 offen nt
    s_add_u32 s7, s7, 13824
    s_mov_b64 exec, s[68:69]
    buffer_load_dwordx4 v[200:203], v66, s[40:43], s7 offen nt
    s_not_b64 exec, exec
    buffer_load_dwordx4 v[200:203], v66, s[44:47], s7 offen nt
    s_add_u32 s7, s7, 13824
    s_mov_b64 exec, s[68:69]
    buffer_load_dwordx4 v[204:207], v66, s[40:43], s7 offen nt
    s_not_b64 exec, exec
    buffer_load_dwordx4 v[204:207], v66, s[44:47], s7 offen nt
    s_add_u32 s7, s7, 13824
    s_waitcnt vmcnt(56)
    s_mov_b64 exec, s[68:69]
    buffer_load_dwordx4 v[208:211], v66, s[40:43], s7 offen nt
    s_not_b64 exec, exec
    buffer_load_dwordx4 v[208:211], v66, s[44:47], s7 offen nt
    s_add_u32 s7, s7, 13824
    s_waitcnt vmcnt(56)
    s_mov_b64 exec, s[68:69]
    buffer_load_dwordx4 v[212:215], v66, s[40:43], s7 offen nt
    s_not_b64 exec, exec
    buffer_load_dwordx4 v[212:215], v66, s[44:47], s7 offen nt
    s_add_u32 s7, s7, 13824
    s_waitcnt vmcnt(56)
    s_mov_b64 exec, s[68:69]
    buffer_load_dwordx4 v[216:219], v66, s[40:43], s7 offen nt
    s_not_b64 exec, exec
    buffer_load_dwordx4 v[216:219], v66, s[44:47], s7 offen nt
    s_add_u32 s7, s7, 13824
    s_waitcnt vmcnt(56)
    s_mov_b64 exec, s[68:69]
    buffer_load_dwordx4 v[220:223], v66, s[40:43], s7 offen nt
    s_not_b64 exec, exec
    buffer_load_dwordx4 v[220:223], v66, s[44:47], s7 offen nt
    s_add_u32 s7, s7, 13824
    s_waitcnt vmcnt(56)
    s_mov_b64 exec, s[68:69]
    buffer_load_dwordx4 v[224:227], v66, s[40:43], s7 offen nt
    s_not_b64 exec, exec
    buffer_load_dwordx4 v[224:227], v66, s[44:47], s7 offen nt
    s_add_u32 s7, s7, 13824
    s_waitcnt vmcnt(56)
    s_mov_b64 exec, s[68:69]
    buffer_load_dwordx4 v[228:231], v66, s[40:43], s7 offen nt
    s_not_b64 exec, exec
    buffer_load_dwordx4 v[228:231], v66, s[44:47], s7 offen nt
    s_mov_b64 exec, -1
L_nof:
    s_setprio 3
    buffer_store_dword v10, v9, s[56:59], s79 offen sc1
    s_mov_b64 exec, 1
    buffer_store_dwordx2 v[10:11], v12, s[56:59], s79 offen offset:2048 sc1
    s_mov_b64 exec, -1
    s_cmp_lt_u32 s70, 46
    s_cbranch_scc0 L_i1
    s_mul_i32 s9, s70, 2560
    s_lshl_b32 s10, s71, 9
    s_add_u32 s10, s10, s9
    s_add_u32 s10, s10, 262144
    buffer_store_dwordx2 v[10:11], v2, s[56:59], s10 offen sc1
L_i1:
    s_lshr_b32 s74, s3, 1
    s_add_u32 s74, s74, 32
    s_lshl_b32 s74, s74, 12
    s_add_u32 s74, s74, 65536
    v_lshlrev_b32 v62, 4, v38
    v_lshl_add_u32 v62, v39, 3, v62
    s_and_b32 s10, s3, 1
    s_lshl_b32 s10, s10, 7
    v_add_u32 v62, s10, v62
    s_cmp_eq_u32 s6, 5
    s_cbranch_scc0 L_i2
    s_cmp_lt_u32 s3, 28
    s_cbranch_scc0 L_i2
    s_cmp_lt_u32 s3, 27
    s_cselect_b32 s10, -1, 0
    v_mov_b32 v36, s10
    v_mov_b32 v37, s10
    v_mov_b32 v34, 0
    v_mov_b32 v35, 1.0
    s_mov_b64 exec, 0x00ff00ff
    buffer_store_dwordx2 v[36:37], v62, s[56:59], s74 offen sc1
    s_mov_b64 exec, 1
    buffer_store_dwordx2 v[34:35], v8, s[56:59], s74 offen offset:2048 sc1
    s_mov_b64 exec, -1
L_i2:
    v_and_b32 v34, 1, v38
    v_lshlrev_b32 v34, 4, v34
    v_mov_b32 v35, 0xffff
    v_lshlrev_b32 v35, v34, v35
    v_bfe_u32 v34, v38, 1, 2
    v_cmp_eq_u32 vcc, 0, v34
    s_nop 1
    v_cndmask_b32 v4, 0, v35, vcc
    v_cmp_eq_u32 vcc, 1, v34
    s_nop 1
    v_cndmask_b32 v5, 0, v35, vcc
    v_cmp_eq_u32 vcc, 2, v34
    s_nop 1
    v_cndmask_b32 v6, 0, v35, vcc
    v_cmp_eq_u32 vcc, 3, v34
    s_nop 1
    v_cndmask_b32 v7, 0, v35, vcc
    s_lshl_b32 s73, s2, 10
    s_add_u32 s73, s73, 786432
    s_waitcnt vmcnt(60)
    v_lshlrev_b32 v40, 16, v40
    v_lshlrev_b32 v41, 16, v41
    v_lshlrev_b32 v42, 16, v42
    v_lshlrev_b32 v43, 16, v43
    v_lshlrev_b32 v44, 16, v44
    v_lshlrev_b32 v45, 16, v45
    v_lshlrev_b32 v46, 16, v46
    v_lshlrev_b32 v47, 16, v47
    v_lshlrev_b32 v48, 16, v48
    v_lshlrev_b32 v49, 16, v49
    v_add_f32 v34, v40, v41
    v_add_f32 v35, v42, v43
    v_add_f32 v36, v44, v45
    v_add_f32 v37, v46, v47
    v_add_f32 v34, v34, v35
    v_add_f32 v36, v36, v37
    v_add_f32 v35, v48, v49
    v_add_f32 v34, v34, v36
    v_add_f32 v34, v34, v35
    s_nop 1
    v_add_f32_dpp v34, v34, v34 row_ror:8 row_mask:0xf bank_mask:0xf
    s_nop 1
    v_add_f32_dpp v34, v34, v34 row_ror:4 row_mask:0xf bank_mask:0xf
    s_nop 1
    v_add_f32_dpp v34, v34, v34 row_ror:2 row_mask:0xf bank_mask:0xf
    s_nop 1
    v_add_f32_dpp v34, v34, v34 row_ror:1 row_mask:0xf bank_mask:0xf
    v_mov_b32 v35, v34
    s_nop 1
    v_permlane16_swap_b32 v35, v34
    v_add_f32 v34, v34, v35
    v_mov_b32 v35, v34
    s_nop 1
    v_permlane32_swap_b32 v35, v34
    v_add_f32 v34, v34, v35
    v_mul_f32 v34, 0x3acccccd, v34
    v_sub_f32 v16, v40, v34
    v_sub_f32 v17, v41, v34
    v_sub_f32 v18, v42, v34
    v_sub_f32 v19, v43, v34
    v_sub_f32 v20, v44, v34
    v_sub_f32 v21, v45, v34
    v_sub_f32 v22, v46, v34
    v_sub_f32 v23, v47, v34
    v_sub_f32 v24, v48, v34
    v_sub_f32 v25, v49, v34
    v_mul_f32 v36, v24, v24
    v_mul_f32 v37, v25, v25
    v_fmac_f32 v36, v16, v16
    v_fmac_f32 v37, v17, v17
    v_fmac_f32 v36, v18, v18
    v_fmac_f32 v37, v19, v19
    v_fmac_f32 v36, v20, v20
    v_fmac_f32 v37, v21, v21
    v_fmac_f32 v36, v22, v22
    v_fmac_f32 v37, v23, v23
    v_add_f32 v36, v36, v37
    s_nop 1
    v_add_f32_dpp v36, v36, v36 row_ror:8 row_mask:0xf bank_mask:0xf
    s_nop 1
    v_add_f32_dpp v36, v36, v36 row_ror:4 row_mask:0xf bank_mask:0xf
    s_nop 1
    v_add_f32_dpp v36, v36, v36 row_ror:2 row_mask:0xf bank_mask:0xf
    s_nop 1
    v_add_f32_dpp v36, v36, v36 row_ror:1 row_mask:0xf bank_mask:0xf
    v_mov_b32 v35, v36
    s_nop 1
    v_permlane16_swap_b32 v35, v36
    v_add_f32 v36, v36, v35
    v_mov_b32 v35, v36
    s_nop 1
    v_permlane32_swap_b32 v35, v36
    v_add_f32 v36, v36, v35
    v_mul_f32 v36, 0x3acccccd, v36
    v_cvt_pk_bf16_f32 v53, v34, v34
    v_and_b32 v53, 0xffff0000, v53
    v_cvt_pk_bf16_f32 v36, v36, v36
    v_and_b32 v36, 0xffff0000, v36
    v_add_f32 v36, 0x3727c5ac, v36
    v_cvt_pk_bf16_f32 v36, v36, v36
    v_and_b32 v36, 0xffff0000, v36
    v_sqrt_f32 v36, v36
    s_nop 0
    v_cvt_pk_bf16_f32 v36, v36, v36
    v_and_b32 v36, 0xffff0000, v36
    v_rcp_f32 v54, v36
    v_sub_f32 v40, v40, v53
    v_sub_f32 v41, v41, v53
    v_sub_f32 v42, v42, v53
    v_sub_f32 v43, v43, v53
    v_sub_f32 v44, v44, v53
    v_cvt_pk_bf16_f32 v40, v40, v40
    v_cvt_pk_bf16_f32 v41, v41, v41
    v_cvt_pk_bf16_f32 v42, v42, v42
    v_cvt_pk_bf16_f32 v43, v43, v43
    v_cvt_pk_bf16_f32 v44, v44, v44
    v_and_b32 v40, 0xffff0000, v40
    v_and_b32 v41, 0xffff0000, v41
    v_and_b32 v42, 0xffff0000, v42
    v_and_b32 v43, 0xffff0000, v43
    v_and_b32 v44, 0xffff0000, v44
    v_mul_f32 v40, v40, v54
    v_mul_f32 v41, v41, v54
    v_mul_f32 v42, v42, v54
    v_mul_f32 v43, v43, v54
    v_mul_f32 v44, v44, v54
    v_cvt_pk_bf16_f32 v40, v40, v40
    v_cvt_pk_bf16_f32 v41, v41, v41
    v_cvt_pk_bf16_f32 v42, v42, v42
    v_cvt_pk_bf16_f32 v43, v43, v43
    v_cvt_pk_bf16_f32 v44, v44, v44
    v_and_b32_dpp v16, v40, v4 row_newbcast:0 row_mask:0xf bank_mask:0xf
    v_and_b32_dpp v17, v40, v5 row_newbcast:0 row_mask:0xf bank_mask:0xf
    v_and_b32_dpp v18, v40, v6 row_newbcast:0 row_mask:0xf bank_mask:0xf
    v_and_b32_dpp v19, v40, v7 row_newbcast:0 row_mask:0xf bank_mask:0xf
    v_and_b32_dpp v20, v41, v4 row_newbcast:0 row_mask:0xf bank_mask:0xf
    v_and_b32_dpp v21, v41, v5 row_newbcast:0 row_mask:0xf bank_mask:0xf
    v_and_b32_dpp v22, v41, v6 row_newbcast:0 row_mask:0xf bank_mask:0xf
    v_and_b32_dpp v23, v41, v7 row_newbcast:0 row_mask:0xf bank_mask:0xf
    s_waitcnt vmcnt(59)
    v_mfma_f32_16x16x32_bf16 v[56:59], v[16:19], v[72:75], 0
    v_and_b32_dpp v16, v42, v4 row_newbcast:0 row_mask:0xf bank_mask:0xf
    v_and_b32_dpp v17, v42, v5 row_newbcast:0 row_mask:0xf bank_mask:0xf
    v_and_b32_dpp v18, v42, v6 row_newbcast:0 row_mask:0xf bank_mask:0xf
    v_and_b32_dpp v19, v42, v7 row_newbcast:0 row_mask:0xf bank_mask:0xf
    s_waitcnt vmcnt(58)
    v_mfma_f32_16x16x32_bf16 v[56:59], v[20:23], v[76:79], v[56:59]
    v_and_b32_dpp v20, v43, v4 row_newbcast:0 row_mask:0xf bank_mask:0xf
    v_and_b32_dpp v21, v43, v5 row_newbcast:0 row_mask:0xf bank_mask:0xf
    v_and_b32_dpp v22, v43, v6 row_newbcast:0 row_mask:0xf bank_mask:0xf
    v_and_b32_dpp v23, v43, v7 row_newbcast:0 row_mask:0xf bank_mask:0xf
    s_waitcnt vmcnt(57)
    v_mfma_f32_16x16x32_bf16 v[56:59], v[16:19], v[80:83], v[56:59]
    v_and_b32_dpp v16, v44, v4 row_newbcast:0 row_mask:0xf bank_mask:0xf
    v_and_b32_dpp v17, v44, v5 row_newbcast:0 row_mask:0xf bank_mask:0xf
    v_and_b32_dpp v18, v44, v6 row_newbcast:0 row_mask:0xf bank_mask:0xf
    v_and_b32_dpp v19, v44, v7 row_newbcast:0 row_mask:0xf bank_mask:0xf
    s_waitcnt vmcnt(56)
    v_mfma_f32_16x16x32_bf16 v[56:59], v[20:23], v[84:87], v[56:59]
    v_and_b32_dpp v20, v40, v4 row_newbcast:1 row_mask:0xf bank_mask:0xf
    v_and_b32_dpp v21, v40, v5 row_newbcast:1 row_mask:0xf bank_mask:0xf
    v_and_b32_dpp v22, v40, v6 row_newbcast:1 row_mask:0xf bank_mask:0xf
    v_and_b32_dpp v23, v40, v7 row_newbcast:1 row_mask:0xf bank_mask:0xf
    s_waitcnt vmcnt(55)
    v_mfma_f32_16x16x32_bf16 v[56:59], v[16:19], v[88:91], v[56:59]
    v_and_b32_dpp v16, v41, v4 row_newbcast:1 row_mask:0xf bank_mask:0xf
    v_and_b32_dpp v17, v41, v5 row_newbcast:1 row_mask:0xf bank_mask:0xf
    v_and_b32_dpp v18, v41, v6 row_newbcast:1 row_mask:0xf bank_mask:0xf
    v_and_b32_dpp v19, v41, v7 row_newbcast:1 row_mask:0xf bank_mask:0xf
    s_waitcnt vmcnt(54)
    v_mfma_f32_16x16x32_bf16 v[56:59], v[20:23], v[92:95], v[56:59]
    v_and_b32_dpp v20, v42, v4 row_newbcast:1 row_mask:0xf bank_mask:0xf
    v_and_b32_dpp v21, v42, v5 row_newbcast:1 row_mask:0xf bank_mask:0xf
    v_and_b32_dpp v22, v42, v6 row_newbcast:1 row_mask:0xf bank_mask:0xf
    v_and_b32_dpp v23, v42, v7 row_newbcast:1 row_mask:0xf bank_mask:0xf
    s_waitcnt vmcnt(53)
    v_mfma_f32_16x16x32_bf16 v[56:59], v[16:19], v[96:99], v[56:59]
    v_and_b32_dpp v16, v43, v4 row_newbcast:1 row_mask:0xf bank_mask:0xf
    v_and_b32_dpp v17, v43, v5 row_newbcast:1 row_mask:0xf bank_mask:0xf
    v_and_b32_dpp v18, v43, v6 row_newbcast:1 row_mask:0xf bank_mask:0xf
    v_and_b32_dpp v19, v43, v7 row_newbcast:1 row_mask:0xf bank_mask:0xf
    s_waitcnt vmcnt(52)
    v_mfma_f32_16x16x32_bf16 v[56:59], v[20:23], v[100:103], v[56:59]
    v_and_b32_dpp v20, v44, v4 row_newbcast:1 row_mask:0xf bank_mask:0xf
    v_and_b32_dpp v21, v44, v5 row_newbcast:1 row_mask:0xf bank_mask:0xf
    v_and_b32_dpp v22, v44, v6 row_newbcast:1 row_mask:0xf bank_mask:0xf
    v_and_b32_dpp v23, v44, v7 row_newbcast:1 row_mask:0xf bank_mask:0xf
    s_waitcnt vmcnt(51)
    v_mfma_f32_16x16x32_bf16 v[56:59], v[16:19], v[104:107], v[56:59]
    v_and_b32_dpp v16, v40, v4 row_newbcast:2 row_mask:0xf bank_mask:0xf
    v_and_b32_dpp v17, v40, v5 row_newbcast:2 row_mask:0xf bank_mask:0xf
    v_and_b32_dpp v18, v40, v6 row_newbcast:2 row_mask:0xf bank_mask:0xf
    v_and_b32_dpp v19, v40, v7 row_newbcast:2 row_mask:0xf bank_mask:0xf
    s_waitcnt vmcnt(50)
    v_mfma_f32_16x16x32_bf16 v[56:59], v[20:23], v[108:111], v[56:59]
    v_and_b32_dpp v20, v41, v4 row_newbcast:2 row_mask:0xf bank_mask:0xf
    v_and_b32_dpp v21, v41, v5 row_newbcast:2 row_mask:0xf bank_mask:0xf
    v_and_b32_dpp v22, v41, v6 row_newbcast:2 row_mask:0xf bank_mask:0xf
    v_and_b32_dpp v23, v41, v7 row_newbcast:2 row_mask:0xf bank_mask:0xf
    s_waitcnt vmcnt(49)
    v_mfma_f32_16x16x32_bf16 v[56:59], v[16:19], v[112:115], v[56:59]
    v_and_b32_dpp v16, v42, v4 row_newbcast:2 row_mask:0xf bank_mask:0xf
    v_and_b32_dpp v17, v42, v5 row_newbcast:2 row_mask:0xf bank_mask:0xf
    v_and_b32_dpp v18, v42, v6 row_newbcast:2 row_mask:0xf bank_mask:0xf
    v_and_b32_dpp v19, v42, v7 row_newbcast:2 row_mask:0xf bank_mask:0xf
    s_waitcnt vmcnt(48)
    v_mfma_f32_16x16x32_bf16 v[56:59], v[20:23], v[116:119], v[56:59]
    v_and_b32_dpp v20, v43, v4 row_newbcast:2 row_mask:0xf bank_mask:0xf
    v_and_b32_dpp v21, v43, v5 row_newbcast:2 row_mask:0xf bank_mask:0xf
    v_and_b32_dpp v22, v43, v6 row_newbcast:2 row_mask:0xf bank_mask:0xf
    v_and_b32_dpp v23, v43, v7 row_newbcast:2 row_mask:0xf bank_mask:0xf
    s_waitcnt vmcnt(47)
    v_mfma_f32_16x16x32_bf16 v[56:59], v[16:19], v[120:123], v[56:59]
    v_and_b32_dpp v16, v44, v4 row_newbcast:2 row_mask:0xf bank_mask:0xf
    v_and_b32_dpp v17, v44, v5 row_newbcast:2 row_mask:0xf bank_mask:0xf
    v_and_b32_dpp v18, v44, v6 row_newbcast:2 row_mask:0xf bank_mask:0xf
    v_and_b32_dpp v19, v44, v7 row_newbcast:2 row_mask:0xf bank_mask:0xf
    s_waitcnt vmcnt(46)
    v_mfma_f32_16x16x32_bf16 v[56:59], v[20:23], v[124:127], v[56:59]
    v_and_b32_dpp v20, v40, v4 row_newbcast:3 row_mask:0xf bank_mask:0xf
    v_and_b32_dpp v21, v40, v5 row_newbcast:3 row_mask:0xf bank_mask:0xf
    v_and_b32_dpp v22, v40, v6 row_newbcast:3 row_mask:0xf bank_mask:0xf
    v_and_b32_dpp v23, v40, v7 row_newbcast:3 row_mask:0xf bank_mask:0xf
    s_waitcnt vmcnt(45)
    v_mfma_f32_16x16x32_bf16 v[56:59], v[16:19], v[128:131], v[56:59]
    v_and_b32_dpp v16, v41, v4 row_newbcast:3 row_mask:0xf bank_mask:0xf
    v_and_b32_dpp v17, v41, v5 row_newbcast:3 row_mask:0xf bank_mask:0xf
    v_and_b32_dpp v18, v41, v6 row_newbcast:3 row_mask:0xf bank_mask:0xf
    v_and_b32_dpp v19, v41, v7 row_newbcast:3 row_mask:0xf bank_mask:0xf
    s_waitcnt vmcnt(44)
    v_mfma_f32_16x16x32_bf16 v[56:59], v[20:23], v[132:135], v[56:59]
    v_and_b32_dpp v20, v42, v4 row_newbcast:3 row_mask:0xf bank_mask:0xf
    v_and_b32_dpp v21, v42, v5 row_newbcast:3 row_mask:0xf bank_mask:0xf
    v_and_b32_dpp v22, v42, v6 row_newbcast:3 row_mask:0xf bank_mask:0xf
    v_and_b32_dpp v23, v42, v7 row_newbcast:3 row_mask:0xf bank_mask:0xf
    s_waitcnt vmcnt(43)
    v_mfma_f32_16x16x32_bf16 v[56:59], v[16:19], v[136:139], v[56:59]
    v_and_b32_dpp v16, v43, v4 row_newbcast:3 row_mask:0xf bank_mask:0xf
    v_and_b32_dpp v17, v43, v5 row_newbcast:3 row_mask:0xf bank_mask:0xf
    v_and_b32_dpp v18, v43, v6 row_newbcast:3 row_mask:0xf bank_mask:0xf
    v_and_b32_dpp v19, v43, v7 row_newbcast:3 row_mask:0xf bank_mask:0xf
    s_waitcnt vmcnt(42)
    v_mfma_f32_16x16x32_bf16 v[56:59], v[20:23], v[140:143], v[56:59]
    v_and_b32_dpp v20, v44, v4 row_newbcast:3 row_mask:0xf bank_mask:0xf
    v_and_b32_dpp v21, v44, v5 row_newbcast:3 row_mask:0xf bank_mask:0xf
    v_and_b32_dpp v22, v44, v6 row_newbcast:3 row_mask:0xf bank_mask:0xf
    v_and_b32_dpp v23, v44, v7 row_newbcast:3 row_mask:0xf bank_mask:0xf
    s_waitcnt vmcnt(41)
    v_mfma_f32_16x16x32_bf16 v[56:59], v[16:19], v[144:147], v[56:59]
    s_waitcnt vmcnt(40)
    v_mfma_f32_16x16x32_bf16 v[56:59], v[20:23], v[148:151], v[56:59]
    s_waitcnt lgkmcnt(0)
    s_mul_i32 s72, s72, 1664525
    s_add_u32 s72, s72, 1013904223
    v_lshlrev_b32 v34, 6, v38
    v_and_b32 v35, 1, v39
    v_lshl_add_u32 v34, v35, 5, v34
    v_lshrrev_b32 v35, 1, v39
    v_lshl_add_u32 v34, v35, 4, v34
    v_mov_b32 v63, v34
    v_lshlrev_b32 v64, 4, v1
    v_add_u32 v65, 0x1000, v64
    s_waitcnt vmcnt(0)
    v_mov_b32 v25, s72
    v_mov_b32 v27, s72
    v_mov_b32 v24, v56
    v_mov_b32 v26, v57
    s_nop 0
    v_mov_b32_dpp v24, v58 quad_perm:[0,1,2,3] row_mask:0xc bank_mask:0xf
    v_mov_b32_dpp v26, v59 quad_perm:[0,1,2,3] row_mask:0xc bank_mask:0xf
    buffer_store_dwordx4 v[24:27], v63, s[56:59], s73 offen sc1
    s_cmp_lt_u32 s3, 27
    s_cbranch_scc0 L_nog
    v_and_b32_dpp v16, v40, v4 row_newbcast:0 row_mask:0xf bank_mask:0xf
    v_and_b32_dpp v17, v40, v5 row_newbcast:0 row_mask:0xf bank_mask:0xf
    v_and_b32_dpp v18, v40, v6 row_newbcast:0 row_mask:0xf bank_mask:0xf
    v_and_b32_dpp v19, v40, v7 row_newbcast:0 row_mask:0xf bank_mask:0xf
    v_and_b32_dpp v20, v41, v4 row_newbcast:0 row_mask:0xf bank_mask:0xf
    v_and_b32_dpp v21, v41, v5 row_newbcast:0 row_mask:0xf bank_mask:0xf
    v_and_b32_dpp v22, v41, v6 row_newbcast:0 row_mask:0xf bank_mask:0xf
    v_and_b32_dpp v23, v41, v7 row_newbcast:0 row_mask:0xf bank_mask:0xf
    v_mfma_f32_16x16x32_bf16 v[56:59], v[16:19], v[152:155], 0
    v_and_b32_dpp v16, v42, v4 row_newbcast:0 row_mask:0xf bank_mask:0xf
    v_and_b32_dpp v17, v42, v5 row_newbcast:0 row_mask:0xf bank_mask:0xf
    v_and_b32_dpp v18, v42, v6 row_newbcast:0 row_mask:0xf bank_mask:0xf
    v_and_b32_dpp v19, v42, v7 row_newbcast:0 row_mask:0xf bank_mask:0xf
    v_mfma_f32_16x16x32_bf16 v[56:59], v[20:23], v[156:159], v[56:59]
    v_and_b32_dpp v20, v43, v4 row_newbcast:0 row_mask:0xf bank_mask:0xf
    v_and_b32_dpp v21, v43, v5 row_newbcast:0 row_mask:0xf bank_mask:0xf
    v_and_b32_dpp v22, v43, v6 row_newbcast:0 row_mask:0xf bank_mask:0xf
    v_and_b32_dpp v23, v43, v7 row_newbcast:0 row_mask:0xf bank_mask:0xf
    v_mfma_f32_16x16x32_bf16 v[56:59], v[16:19], v[160:163], v[56:59]
    v_and_b32_dpp v16, v44, v4 row_newbcast:0 row_mask:0xf bank_mask:0xf
    v_and_b32_dpp v17, v44, v5 row_newbcast:0 row_mask:0xf bank_mask:0xf
    v_and_b32_dpp v18, v44, v6 row_newbcast:0 row_mask:0xf bank_mask:0xf
    v_and_b32_dpp v19, v44, v7 row_newbcast:0 row_mask:0xf bank_mask:0xf
    v_mfma_f32_16x16x32_bf16 v[56:59], v[20:23], v[164:167], v[56:59]
    v_and_b32_dpp v20, v40, v4 row_newbcast:1 row_mask:0xf bank_mask:0xf
    v_and_b32_dpp v21, v40, v5 row_newbcast:1 row_mask:0xf bank_mask:0xf
    v_and_b32_dpp v22, v40, v6 row_newbcast:1 row_mask:0xf bank_mask:0xf
    v_and_b32_dpp v23, v40, v7 row_newbcast:1 row_mask:0xf bank_mask:0xf
    v_mfma_f32_16x16x32_bf16 v[56:59], v[16:19], v[168:171], v[56:59]
    v_and_b32_dpp v16, v41, v4 row_newbcast:1 row_mask:0xf bank_mask:0xf
    v_and_b32_dpp v17, v41, v5 row_newbcast:1 row_mask:0xf bank_mask:0xf
    v_and_b32_dpp v18, v41, v6 row_newbcast:1 row_mask:0xf bank_mask:0xf
    v_and_b32_dpp v19, v41, v7 row_newbcast:1 row_mask:0xf bank_mask:0xf
    v_mfma_f32_16x16x32_bf16 v[56:59], v[20:23], v[172:175], v[56:59]
    v_and_b32_dpp v20, v42, v4 row_newbcast:1 row_mask:0xf bank_mask:0xf
    v_and_b32_dpp v21, v42, v5 row_newbcast:1 row_mask:0xf bank_mask:0xf
    v_and_b32_dpp v22, v42, v6 row_newbcast:1 row_mask:0xf bank_mask:0xf
    v_and_b32_dpp v23, v42, v7 row_newbcast:1 row_mask:0xf bank_mask:0xf
    v_mfma_f32_16x16x32_bf16 v[56:59], v[16:19], v[176:179], v[56:59]
    v_and_b32_dpp v16, v43, v4 row_newbcast:1 row_mask:0xf bank_mask:0xf
    v_and_b32_dpp v17, v43, v5 row_newbcast:1 row_mask:0xf bank_mask:0xf
    v_and_b32_dpp v18, v43, v6 row_newbcast:1 row_mask:0xf bank_mask:0xf
    v_and_b32_dpp v19, v43, v7 row_newbcast:1 row_mask:0xf bank_mask:0xf
    v_mfma_f32_16x16x32_bf16 v[56:59], v[20:23], v[180:183], v[56:59]
    v_and_b32_dpp v20, v44, v4 row_newbcast:1 row_mask:0xf bank_mask:0xf
    v_and_b32_dpp v21, v44, v5 row_newbcast:1 row_mask:0xf bank_mask:0xf
    v_and_b32_dpp v22, v44, v6 row_newbcast:1 row_mask:0xf bank_mask:0xf
    v_and_b32_dpp v23, v44, v7 row_newbcast:1 row_mask:0xf bank_mask:0xf
    v_mfma_f32_16x16x32_bf16 v[56:59], v[16:19], v[184:187], v[56:59]
    v_and_b32_dpp v16, v40, v4 row_newbcast:2 row_mask:0xf bank_mask:0xf
    v_and_b32_dpp v17, v40, v5 row_newbcast:2 row_mask:0xf bank_mask:0xf
    v_and_b32_dpp v18, v40, v6 row_newbcast:2 row_mask:0xf bank_mask:0xf
    v_and_b32_dpp v19, v40, v7 row_newbcast:2 row_mask:0xf bank_mask:0xf
    v_mfma_f32_16x16x32_bf16 v[56:59], v[20:23], v[188:191], v[56:59]
    v_and_b32_dpp v20, v41, v4 row_newbcast:2 row_mask:0xf bank_mask:0xf
    v_and_b32_dpp v21, v41, v5 row_newbcast:2 row_mask:0xf bank_mask:0xf
    v_and_b32_dpp v22, v41, v6 row_newbcast:2 row_mask:0xf bank_mask:0xf
    v_and_b32_dpp v23, v41, v7 row_newbcast:2 row_mask:0xf bank_mask:0xf
    v_mfma_f32_16x16x32_bf16 v[56:59], v[16:19], v[192:195], v[56:59]
    v_and_b32_dpp v16, v42, v4 row_newbcast:2 row_mask:0xf bank_mask:0xf
    v_and_b32_dpp v17, v42, v5 row_newbcast:2 row_mask:0xf bank_mask:0xf
    v_and_b32_dpp v18, v42, v6 row_newbcast:2 row_mask:0xf bank_mask:0xf
    v_and_b32_dpp v19, v42, v7 row_newbcast:2 row_mask:0xf bank_mask:0xf
    v_mfma_f32_16x16x32_bf16 v[56:59], v[20:23], v[196:199], v[56:59]
    v_and_b32_dpp v20, v43, v4 row_newbcast:2 row_mask:0xf bank_mask:0xf
    v_and_b32_dpp v21, v43, v5 row_newbcast:2 row_mask:0xf bank_mask:0xf
    v_and_b32_dpp v22, v43, v6 row_newbcast:2 row_mask:0xf bank_mask:0xf
    v_and_b32_dpp v23, v43, v7 row_newbcast:2 row_mask:0xf bank_mask:0xf
    v_mfma_f32_16x16x32_bf16 v[56:59], v[16:19], v[200:203], v[56:59]
    v_and_b32_dpp v16, v44, v4 row_newbcast:2 row_mask:0xf bank_mask:0xf
    v_and_b32_dpp v17, v44, v5 row_newbcast:2 row_mask:0xf bank_mask:0xf
    v_and_b32_dpp v18, v44, v6 row_newbcast:2 row_mask:0xf bank_mask:0xf
    v_and_b32_dpp v19, v44, v7 row_newbcast:2 row_mask:0xf bank_mask:0xf
    v_mfma_f32_16x16x32_bf16 v[56:59], v[20:23], v[204:207], v[56:59]
    v_and_b32_dpp v20, v40, v4 row_newbcast:3 row_mask:0xf bank_mask:0xf
    v_and_b32_dpp v21, v40, v5 row_newbcast:3 row_mask:0xf bank_mask:0xf
    v_and_b32_dpp v22, v40, v6 row_newbcast:3 row_mask:0xf bank_mask:0xf
    v_and_b32_dpp v23, v40, v7 row_newbcast:3 row_mask:0xf bank_mask:0xf
    v_mfma_f32_16x16x32_bf16 v[56:59], v[16:19], v[208:211], v[56:59]
    v_and_b32_dpp v16, v41, v4 row_newbcast:3 row_mask:0xf bank_mask:0xf
    v_and_b32_dpp v17, v41, v5 row_newbcast:3 row_mask:0xf bank_mask:0xf
    v_and_b32_dpp v18, v41, v6 row_newbcast:3 row_mask:0xf bank_mask:0xf
    v_and_b32_dpp v19, v41, v7 row_newbcast:3 row_mask:0xf bank_mask:0xf
    v_mfma_f32_16x16x32_bf16 v[56:59], v[20:23], v[212:215], v[56:59]
    v_and_b32_dpp v20, v42, v4 row_newbcast:3 row_mask:0xf bank_mask:0xf
    v_and_b32_dpp v21, v42, v5 row_newbcast:3 row_mask:0xf bank_mask:0xf
    v_and_b32_dpp v22, v42, v6 row_newbcast:3 row_mask:0xf bank_mask:0xf
    v_and_b32_dpp v23, v42, v7 row_newbcast:3 row_mask:0xf bank_mask:0xf
    v_mfma_f32_16x16x32_bf16 v[56:59], v[16:19], v[216:219], v[56:59]
    v_and_b32_dpp v16, v43, v4 row_newbcast:3 row_mask:0xf bank_mask:0xf
    v_and_b32_dpp v17, v43, v5 row_newbcast:3 row_mask:0xf bank_mask:0xf
    v_and_b32_dpp v18, v43, v6 row_newbcast:3 row_mask:0xf bank_mask:0xf
    v_and_b32_dpp v19, v43, v7 row_newbcast:3 row_mask:0xf bank_mask:0xf
    v_mfma_f32_16x16x32_bf16 v[56:59], v[20:23], v[220:223], v[56:59]
    v_and_b32_dpp v20, v44, v4 row_newbcast:3 row_mask:0xf bank_mask:0xf
    v_and_b32_dpp v21, v44, v5 row_newbcast:3 row_mask:0xf bank_mask:0xf
    v_and_b32_dpp v22, v44, v6 row_newbcast:3 row_mask:0xf bank_mask:0xf
    v_and_b32_dpp v23, v44, v7 row_newbcast:3 row_mask:0xf bank_mask:0xf
    v_mfma_f32_16x16x32_bf16 v[56:59], v[16:19], v[224:227], v[56:59]
    s_nop 0
    v_mfma_f32_16x16x32_bf16 v[56:59], v[20:23], v[228:231], v[56:59]
    s_add_u32 s73, s73, 262144
    v_mov_b32 v25, s72
    v_mov_b32 v27, s72
    s_nop 4
    v_mov_b32 v24, v56
    v_mov_b32 v26, v57
    s_nop 0
    v_mov_b32_dpp v24, v58 quad_perm:[0,1,2,3] row_mask:0xc bank_mask:0xf
    v_mov_b32_dpp v26, v59 quad_perm:[0,1,2,3] row_mask:0xc bank_mask:0xf
    buffer_store_dwordx4 v[24:27], v63, s[56:59], s73 offen sc1
L_nog:
    s_lshl_b32 s10, s3, 13
    s_add_u32 s10, s10, 786432
L_pq:
    buffer_load_dwordx4 v[72:75], v64, s[56:59], s10 offen offset:0 sc1
    buffer_load_dwordx4 v[76:79], v64, s[56:59], s10 offen offset:1024 sc1
    buffer_load_dwordx4 v[80:83], v64, s[56:59], s10 offen offset:2048 sc1
    buffer_load_dwordx4 v[84:87], v64, s[56:59], s10 offen offset:3072 sc1
    buffer_load_dwordx4 v[88:91], v65, s[56:59], s10 offen offset:0 sc1
    buffer_load_dwordx4 v[92:95], v65, s[56:59], s10 offen offset:1024 sc1
    buffer_load_dwordx4 v[96:99], v65, s[56:59], s10 offen offset:2048 sc1
    buffer_load_dwordx4 v[100:103], v65, s[56:59], s10 offen offset:3072 sc1
    s_waitcnt vmcnt(0)
    v_xor_b32 v34, s72, v73
    v_xor_b32 v75, s72, v75
    v_xor_b32 v77, s72, v77
    v_xor_b32 v79, s72, v79
    v_xor_b32 v81, s72, v81
    v_xor_b32 v83, s72, v83
    v_xor_b32 v85, s72, v85
    v_xor_b32 v87, s72, v87
    v_xor_b32 v89, s72, v89
    v_xor_b32 v91, s72, v91
    v_xor_b32 v93, s72, v93
    v_xor_b32 v95, s72, v95
    v_xor_b32 v97, s72, v97
    v_xor_b32 v99, s72, v99
    v_xor_b32 v101, s72, v101
    v_xor_b32 v103, s72, v103
    v_or3_b32 v34, v34, v75, v77
    v_or3_b32 v34, v34, v79, v81
    v_or3_b32 v34, v34, v83, v85
    v_or3_b32 v34, v34, v87, v89
    v_or3_b32 v34, v34, v91, v93
    v_or3_b32 v34, v34, v95, v97
    v_or3_b32 v34, v34, v99, v101
    v_or_b32 v34, v34, v103
    v_cmp_ne_u32 vcc, 0, v34
    s_add_u32 s15, s15, 1
    s_cmp_gt_u32 s15, 1048576
    s_cbranch_scc1 L_pq_ok
    s_cbranch_vccnz L_pq
L_pq_ok:
    v_add_f32 v72, v72, v88
    v_add_f32 v74, v74, v90
    v_add_f32 v76, v76, v92
    v_add_f32 v78, v78, v94
    v_add_f32 v80, v80, v96
    v_add_f32 v82, v82, v98
    v_add_f32 v84, v84, v100
    v_add_f32 v86, v86, v102
    v_add_f32 v72, v72, v80
    v_add_f32 v74, v74, v82
    v_add_f32 v76, v76, v84
    v_add_f32 v78, v78, v86
    v_add_f32 v72, v72, v76
    v_add_f32 v74, v74, v78
    v_cvt_pk_bf16_f32 v16, v72, v74
    v_min_u32 v16, -2, v16
    ds_write_b32 v3, v16 offset:2048
    s_mov_b32 s64, s38
    s_mov_b32 s65, s39
    s_mov_b32 s66, 0
    s_mov_b32 s67, 0x20000
    s_mov_b32 s60, s34
    s_mov_b32 s61, s35
    s_mov_b32 s62, 0
    s_mov_b32 s63, 0x20000
    s_mov_b32 s77, -1
    v_mov_b32 v15, 0
    v_mov_b32 v60, 0
    v_mov_b32 v61, 0
    s_cmp_lt_u32 s6, 5
    s_cbranch_scc1 L_tail0
    s_cmp_eq_u32 s6, 5
    s_cbranch_scc1 L_ffn
    s_add_u32 s7, s3, 32
    s_cmp_lt_u32 s3, 8
    s_cselect_b32 s77, s7, -1
    s_cmp_eq_u32 s6, 6
    s_cselect_b32 s77, s3, s77
L_chk:
    s_cmp_lt_u32 s70, 46
    s_cbranch_scc0 L_tail0
    s_lshl_b32 s7, s70, 1
    s_sub_u32 s7, s7, 64
    v_and_b32 v34, 1, v1
    v_add_u32 v34, s7, v34
    v_sub_u32 v35, 5, v34
    v_and_b32 v35, 7, v35
    v_lshl_add_u32 v35, v34, 3, v35
    s_cmp_eq_u32 s77, -1
    s_cselect_b32 s8, 0, 0x10000
    s_cbranch_scc1 L_chk2
    v_mov_b32 v35, v1
    v_lshlrev_b32 v34, 1, v38
    s_lshl_b32 s7, s77, 5
    buffer_load_ushort v14, v34, s[48:51], s7 offen
L_chk2:
    v_lshlrev_b32 v35, 10, v35
    s_mov_b32 s80, 786432
    s_add_u32 s81, s80, s8
    s_add_u32 s82, s81, s8
    s_add_u32 s83, s82, s8
L_paf:
    s_sleep 60
    buffer_load_dwordx4 v[72:75], v35, s[56:59], s80 offen sc1
    buffer_load_dwordx4 v[76:79], v35, s[56:59], s81 offen sc1
    buffer_load_dwordx4 v[80:83], v35, s[56:59], s82 offen sc1
    buffer_load_dwordx4 v[84:87], v35, s[56:59], s83 offen sc1
    s_waitcnt vmcnt(0)
    v_xor_b32 v34, s72, v73
    v_xor_b32 v75, s72, v75
    v_xor_b32 v77, s72, v77
    v_xor_b32 v79, s72, v79
    v_xor_b32 v81, s72, v81
    v_xor_b32 v83, s72, v83
    v_xor_b32 v85, s72, v85
    v_xor_b32 v87, s72, v87
    v_or3_b32 v34, v34, v75, v77
    v_or3_b32 v34, v34, v79, v81
    v_or3_b32 v34, v34, v83, v85
    v_or_b32 v34, v34, v87
    v_cmp_ne_u32 vcc, 0, v34
    s_add_u32 s15, s15, 1
    s_cmp_gt_u32 s15, 1048576
    s_cbranch_scc1 L_paf_ok
    s_cbranch_vccnz L_paf
L_paf_ok:
    s_cmp_lg_u32 s77, 0
    s_cbranch_scc1 L_noR
    v_mov_b32 v34, s72
    s_mov_b32 s7, 720900
    s_mov_b64 exec, 1
    buffer_store_dword v34, v8, s[56:59], s7 offen sc1
    s_mov_b64 exec, -1
L_noR:
    v_lshlrev_b32 v14, 16, v14
    v_mul_u32_u24 v15, 2560, v39
    v_lshl_add_u32 v15, v38, 2, v15
    v_add_u32 v60, 81920, v15
    v_cmp_lt_u32 vcc, 1, v39
    v_mov_b32 v61, 0x7ff00000
    s_nop 0
    v_cndmask_b32 v61, v60, v61, vcc
    s_lshl_b32 s7, s77, 6
    s_add_u32 s80, s7, 262144
    s_add_u32 s81, s80, 10240
    s_add_u32 s82, s81, 10240
    s_add_u32 s83, s82, 10240
    s_add_u32 s84, s83, 10240
    s_add_u32 s85, s84, 10240
    s_add_u32 s86, s85, 10240
    s_add_u32 s87, s86, 10240
    s_branch L_tail0
L_ffn:
    s_cmp_lt_u32 s3, 27
    s_cbranch_scc0 L_tail0
    s_add_u32 s10, s10, 262144
L_pg:
    s_sleep 60
    buffer_load_dwordx4 v[72:75], v64, s[56:59], s10 offen offset:0 sc1
    buffer_load_dwordx4 v[76:79], v64, s[56:59], s10 offen offset:1024 sc1
    buffer_load_dwordx4 v[80:83], v64, s[56:59], s10 offen offset:2048 sc1
    buffer_load_dwordx4 v[84:87], v64, s[56:59], s10 offen offset:3072 sc1
    buffer_load_dwordx4 v[88:91], v65, s[56:59], s10 offen offset:0 sc1
    buffer_load_dwordx4 v[92:95], v65, s[56:59], s10 offen offset:1024 sc1
    buffer_load_dwordx4 v[96:99], v65, s[56:59], s10 offen offset:2048 sc1
    buffer_load_dwordx4 v[100:103], v65, s[56:59], s10 offen offset:3072 sc1
    s_waitcnt vmcnt(0)
    v_xor_b32 v34, s72, v73
    v_xor_b32 v75, s72, v75
    v_xor_b32 v77, s72, v77
    v_xor_b32 v79, s72, v79
    v_xor_b32 v81, s72, v81
    v_xor_b32 v83, s72, v83
    v_xor_b32 v85, s72, v85
    v_xor_b32 v87, s72, v87
    v_xor_b32 v89, s72, v89
    v_xor_b32 v91, s72, v91
    v_xor_b32 v93, s72, v93
    v_xor_b32 v95, s72, v95
    v_xor_b32 v97, s72, v97
    v_xor_b32 v99, s72, v99
    v_xor_b32 v101, s72, v101
    v_xor_b32 v103, s72, v103
    v_or3_b32 v34, v34, v75, v77
    v_or3_b32 v34, v34, v79, v81
    v_or3_b32 v34, v34, v83, v85
    v_or3_b32 v34, v34, v87, v89
    v_or3_b32 v34, v34, v91, v93
    v_or3_b32 v34, v34, v95, v97
    v_or3_b32 v34, v34, v99, v101
    v_or_b32 v34, v34, v103
    v_cmp_ne_u32 vcc, 0, v34
    s_add_u32 s15, s15, 1
    s_cmp_gt_u32 s15, 1048576
    s_cbranch_scc1 L_pg_ok
    s_cbranch_vccnz L_pg
L_pg_ok:
    v_add_f32 v72, v72, v88
    v_add_f32 v74, v74, v90
    v_add_f32 v76, v76, v92
    v_add_f32 v78, v78, v94
    v_add_f32 v80, v80, v96
    v_add_f32 v82, v82, v98
    v_add_f32 v84, v84, v100
    v_add_f32 v86, v86, v102
    v_add_f32 v72, v72, v80
    v_add_f32 v74, v74, v82
    v_add_f32 v76, v76, v84
    v_add_f32 v78, v78, v86
    v_add_f32 v72, v72, v76
    v_add_f32 v74, v74, v78
    v_cvt_pk_bf16_f32 v40, v72, v72
    v_and_b32 v40, 0xffff0000, v40
    v_cvt_pk_bf16_f32 v41, v74, v74
    v_and_b32 v41, 0xffff0000, v41
    v_mov_b32 v42, v40
    v_mov_b32 v43, v41
    s_nop 0
    v_permlane32_swap_b32 v40, v42
    v_permlane32_swap_b32 v41, v43
    s_mov_b32 s9, 0x3d372713
    v_mul_f32 v44, v40, v40
    v_mul_f32 v44, v44, v40
    v_fma_f32 v44, v44, s9, v40
    v_mul_f32 v44, 0xc0135761, v44
    v_exp_f32 v44, v44
    s_nop 0
    v_add_f32 v44, 1.0, v44
    v_rcp_f32 v44, v44
    s_nop 0
    v_mul_f32 v44, v44, v40
    v_cvt_pk_bf16_f32 v44, v44, v44
    v_and_b32 v44, 0xffff0000, v44
    v_mul_f32 v44, v44, v42
    v_mul_f32 v45, v41, v41
    v_mul_f32 v45, v45, v41
    v_fma_f32 v45, v45, s9, v41
    v_mul_f32 v45, 0xc0135761, v45
    v_exp_f32 v45, v45
    s_nop 0
    v_add_f32 v45, 1.0, v45
    v_rcp_f32 v45, v45
    s_nop 0
    v_mul_f32 v45, v45, v41
    v_cvt_pk_bf16_f32 v45, v45, v45
    v_and_b32 v45, 0xffff0000, v45
    v_mul_f32 v45, v45, v43
    v_cvt_pk_bf16_f32 v34, v44, v45
    v_min_u32 v34, -2, v34
    s_and_b32 s10, s3, 1
    s_lshl_b32 s10, s10, 7
    s_add_u32 s10, s10, s74
    s_mov_b32 exec_hi, 0
    buffer_store_dword v34, v3, s[56:59], s10 offen sc1
    s_mov_b64 exec, -1
    s_branch L_chk
L_tail0:
    s_mov_b32 s76, 0
    s_branch L_tail2
L_tail1:
    s_mov_b32 s66, 1310720
    s_mov_b32 s62, 1280
    s_mov_b32 s11, 55
    s_mov_b32 s12, 655360
    s_mov_b32 s74, 61
    s_lshl_b32 s7, s4, 2
    s_and_b32 s8, s4, 1
    s_add_u32 s7, s7, s8
    s_add_u32 s7, s7, 2
    s_cmp_eq_u32 s7, s3
    s_cselect_b32 s14, 107, 0
    s_lshr_b32 s14, s14, s4
    s_and_b32 s14, s14, 1
    s_lshl_b32 s7, s4, 7
    v_add_u32 v37, s7, v2
    v_mov_b32 v24, 0
    v_mov_b32 v26, 0
    v_mov_b32 v27, 0
    v_mov_b32 v25, 0
    v_mov_b32 v29, 0
    v_mov_b32 v28, -1
    v_mov_b32 v19, s72
    v_and_b32 v31, 24, v1
    v_lshrrev_b32 v30, 1, v31
    v_and_b32 v36, 7, v1
    v_lshlrev_b32 v36, 7, v36
    s_mov_b32 s75, 0x6b6b6b6b
    s_mov_b32 s78, 0
    s_mov_b32 exec_hi, 0
    s_mov_b64 exec, -1
    s_mov_b32 s75, 107
    v_mov_b32 v30, 4
L_hp:
    s_sleep 4
    ds_read_b32 v16, v30 offset:1024
    s_waitcnt lgkmcnt(0)
    v_readfirstlane_b32 s13, v16
    s_nop 0
    s_cmp_gt_u32 s13, s11
    s_cbranch_scc1 L_hp
    s_memrealtime s[68:69]
    s_waitcnt lgkmcnt(0)
    s_cmp_eq_u32 s13, s11
    s_cselect_b32 s7, s14, 0
    s_cmp_ge_i32 s11, 8
    s_cselect_b32 s7, s7, 0
    s_cmp_eq_u32 s7, 0
    s_cbranch_scc1 L_hr
    v_mov_b32 v18, s68
    s_mov_b64 exec, 0xffff
    buffer_store_dwordx2 v[18:19], v37, s[56:59], s12 offen offset:1024 sc1
L_hr:
    s_add_u32 s74, s11, 6
    s_cmp_gt_u32 s74, 55
    s_cbranch_scc1 L_hs
    s_mov_b32 exec_lo, s75
    s_mov_b32 exec_hi, 0
    s_cbranch_execz L_hs
    buffer_load_dwordx2 v[26:27], v36, s[56:59], s12 offen sc1
    s_sub_u32 s7, 55, s74
    v_cvt_f32_u32 v20, s7
    v_rcp_f32 v20, v20
    s_waitcnt vmcnt(0)
    v_cmp_eq_u32 vcc, s72, v27
    s_nop 0
    s_mov_b32 s78, vcc_lo
    s_cmp_eq_u32 s74, 55
    s_cbranch_scc0 L_ht
    v_mov_b32 v24, v26
    s_mov_b32 s75, s78
    s_branch L_hs
L_ht:
    s_bcnt1_i32_b32 s69, s78
    s_cmp_lt_u32 s69, 3
    s_cbranch_scc1 L_hs
    v_sub_u32 v25, v26, v24
    v_cvt_f32_u32 v25, v25
    v_mul_f32 v25, v25, v20
    v_mul_f32 v20, 0x41100000, v25
    v_cvt_i32_f32 v20, v20
    v_subrev_u32 v21, s68, v26
    v_add_u32 v20, v20, v21
    v_lshl_add_u32 v20, v20, 3, v1
    v_mov_b32 v21, 0x7fffffff
    v_cndmask_b32 v20, v21, v20, vcc
    v_mov_b32 v21, 0
    s_mov_b32 exec_lo, 0xff
    v_readlane_b32 s7, v20, 0
    s_bitcmp1_b32 s78, 0
    s_cselect_b32 s7, s7, 0x7fffffff
    v_cmp_lt_i32 vcc, s7, v20
    s_nop 1
    v_addc_co_u32 v21, vcc, 0, v21, vcc
    v_readlane_b32 s7, v20, 1
    s_bitcmp1_b32 s78, 1
    s_cselect_b32 s7, s7, 0x7fffffff
    v_cmp_lt_i32 vcc, s7, v20
    s_nop 1
    v_addc_co_u32 v21, vcc, 0, v21, vcc
    v_readlane_b32 s7, v20, 3
    s_bitcmp1_b32 s78, 3
    s_cselect_b32 s7, s7, 0x7fffffff
    v_cmp_lt_i32 vcc, s7, v20
    s_nop 1
    v_addc_co_u32 v21, vcc, 0, v21, vcc
    v_readlane_b32 s7, v20, 5
    s_bitcmp1_b32 s78, 5
    s_cselect_b32 s7, s7, 0x7fffffff
    v_cmp_lt_i32 vcc, s7, v20
    s_nop 1
    v_addc_co_u32 v21, vcc, 0, v21, vcc
    v_readlane_b32 s7, v20, 6
    s_bitcmp1_b32 s78, 6
    s_cselect_b32 s7, s7, 0x7fffffff
    v_cmp_lt_i32 vcc, s7, v20
    s_nop 1
    v_addc_co_u32 v21, vcc, 0, v21, vcc
    s_sub_u32 s69, s69, 1
    s_lshr_b32 s69, s69, 1
    v_cmp_eq_u32 vcc, s69, v21
    s_nop 0
    s_and_b32 s7, vcc_lo, s78
    s_ff1_i32_b32 s7, s7
    v_readlane_b32 s8, v26, s7
    v_readlane_b32 s9, v25, s7
    s_mov_b64 exec, -1
    v_sub_u32 v20, s74, v1
    v_cvt_f32_i32 v20, v20
    v_mul_f32 v20, s9, v20
    v_cvt_i32_f32 v20, v20
    v_add_u32 v20, s8, v20
    ds_write_b32 v3, v20 offset:1536
L_hs:
    s_mov_b64 exec, -1
    s_add_u32 s12, s12, 1024
    s_sub_u32 s11, s11, 6
    s_cmp_ge_i32 s11, 2
    s_cbranch_scc1 L_hp
    s_mov_b64 exec, -1
    s_waitcnt vmcnt(0)
    s_barrier
L_tail2:
    ds_read_b128 v[16:19], v8 offset:4352
    ds_read_b128 v[20:23], v8 offset:4368
    s_waitcnt lgkmcnt(0)
    v_max_f32 v34, v16, v18
    v_max3_f32 v34, v34, v20, v22
    v_sub_f32 v16, v16, v34
    v_sub_f32 v18, v18, v34
    v_sub_f32 v20, v20, v34
    v_sub_f32 v22, v22, v34
    v_mul_f32 v16, 0x3fb8aa3b, v16
    v_mul_f32 v18, 0x3fb8aa3b, v18
    v_mul_f32 v20, 0x3fb8aa3b, v20
    v_mul_f32 v22, 0x3fb8aa3b, v22
    v_exp_f32 v16, v16
    v_exp_f32 v18, v18
    v_exp_f32 v20, v20
    v_exp_f32 v22, v22
    v_mul_f32 v35, v16, v17
    v_fmac_f32 v35, v18, v19
    v_fmac_f32 v35, v20, v21
    v_fmac_f32 v35, v22, v23
    v_rcp_f32 v36, v35
    s_nop 0
    v_mul_f32 v16, v16, v36
    v_mul_f32 v18, v18, v36
    v_mul_f32 v20, v20, v36
    v_mul_f32 v22, v22, v36
    v_min_u32 v34, -2, v34
    v_min_u32 v35, -2, v35
    s_mov_b64 exec, 1
    buffer_store_dwordx2 v[34:35], v12, s[64:67], s79 offen offset:2048 sc1
    s_mov_b64 exec, -1
    s_cmp_eq_u32 s76, 0
    s_cbranch_scc1 L_tail3
    s_barrier
L_tail3:
    ds_read_b64 v[24:25], v2 offset:2304
    ds_read_b64 v[26:27], v2 offset:2816
    ds_read_b64 v[28:29], v2 offset:3328
    ds_read_b64 v[30:31], v2 offset:3840
    s_waitcnt lgkmcnt(0)
    v_mul_f32 v24, v16, v24
    v_mul_f32 v25, v16, v25
    v_fmac_f32 v24, v18, v26
    v_fmac_f32 v25, v18, v27
    v_fmac_f32 v24, v20, v28
    v_fmac_f32 v25, v20, v29
    v_fmac_f32 v24, v22, v30
    v_fmac_f32 v25, v22, v31
    v_cvt_pk_bf16_f32 v24, v24, v25
    v_min_u32 v24, -2, v24
    buffer_store_dword v24, v9, s[64:67], s79 offen sc1
    s_cmp_eq_u32 s76, 0
    s_cbranch_scc1 L_tfin
    s_cmp_lt_u32 s70, 46
    s_cbranch_scc0 L_tend
    s_barrier
    s_barrier
L_tfin:
    s_cmp_eq_u32 s77, -1
    s_cbranch_scc1 L_tend
L_pd:
    buffer_load_dword v16, v60, s[64:67], s80 offen sc1
    buffer_load_dword v17, v60, s[64:67], s81 offen sc1
    buffer_load_dword v18, v60, s[64:67], s82 offen sc1
    buffer_load_dword v19, v61, s[64:67], s83 offen sc1
    buffer_load_dword v72, v15, s[64:67], s80 offen sc1
    buffer_load_dword v73, v15, s[64:67], s81 offen sc1
    buffer_load_dword v74, v15, s[64:67], s82 offen sc1
    buffer_load_dword v75, v15, s[64:67], s83 offen sc1
    buffer_load_dword v76, v15, s[64:67], s84 offen sc1
    buffer_load_dword v77, v15, s[64:67], s85 offen sc1
    buffer_load_dword v78, v15, s[64:67], s86 offen sc1
    buffer_load_dword v79, v15, s[64:67], s87 offen sc1
    s_waitcnt vmcnt(8)
    v_max_u32 v34, v16, v17
    v_max3_u32 v34, v34, v18, v19
    v_cmp_eq_u32 vcc, -1, v34
    s_add_u32 s15, s15, 1
    s_cmp_gt_u32 s15, 1048576
    s_cbranch_scc1 L_pd_ok
    s_cbranch_vccnz L_pd
L_pd_ok:
    v_add_f32 v16, v16, v17
    v_add_f32 v18, v18, v19
    v_add_f32 v16, v16, v18
    v_mov_b32 v35, v16
    s_nop 1
    v_permlane16_swap_b32 v35, v16
    v_add_f32 v16, v16, v35
    v_mov_b32 v35, v16
    s_nop 1
    v_permlane32_swap_b32 v35, v16
    v_add_f32 v16, v16, v35
    v_cvt_pk_bf16_f32 v16, v16, v16
    v_and_b32 v16, 0xffff0000, v16
    v_mul_f32 v34, 0xbfb8aa3b, v16
    v_exp_f32 v34, v34
    s_nop 0
    v_add_f32 v34, 1.0, v34
    v_rcp_f32 v34, v34
    s_nop 0
    v_mul_f32 v13, v16, v34
    v_cvt_pk_bf16_f32 v13, v13, v13
    v_and_b32 v13, 0xffff0000, v13
    v_lshlrev_b32 v36, 1, v38
    s_lshl_b32 s7, s77, 5
L_p2:
    s_waitcnt vmcnt(0)
    v_max3_u32 v34, v72, v73, v74
    v_max3_u32 v35, v75, v76, v77
    v_add_f32 v16, v72, v76
    v_add_f32 v17, v73, v77
    v_add_f32 v18, v74, v78
    v_add_f32 v19, v75, v79
    v_max3_u32 v34, v34, v78, v79
    v_max_u32 v34, v34, v35
    v_cmp_eq_u32 vcc, -1, v34
    s_cbranch_vccz L_p2_ok
    buffer_load_dword v72, v15, s[64:67], s80 offen sc1
    buffer_load_dword v73, v15, s[64:67], s81 offen sc1
    buffer_load_dword v74, v15, s[64:67], s82 offen sc1
    buffer_load_dword v75, v15, s[64:67], s83 offen sc1
    buffer_load_dword v76, v15, s[64:67], s84 offen sc1
    buffer_load_dword v77, v15, s[64:67], s85 offen sc1
    buffer_load_dword v78, v15, s[64:67], s86 offen sc1
    buffer_load_dword v79, v15, s[64:67], s87 offen sc1
    s_add_u32 s15, s15, 1
    s_cmp_gt_u32 s15, 1048576
    s_cbranch_scc0 L_p2
L_p2_ok:
    v_add_f32 v16, v16, v18
    v_add_f32 v17, v17, v19
    v_add_f32 v16, v16, v17
    v_mov_b32 v35, v16
    s_nop 1
    v_permlane16_swap_b32 v35, v16
    v_add_f32 v16, v16, v35
    v_mov_b32 v35, v16
    s_nop 1
    v_permlane32_swap_b32 v35, v16
    v_add_f32 v16, v16, v35
    v_cvt_pk_bf16_f32 v16, v16, v16
    v_and_b32 v16, 0xffff0000, v16
    v_mul_f32 v16, v16, v13
    v_cvt_pk_bf16_f32 v16, v16, v16
    v_and_b32 v16, 0xffff0000, v16
    v_add_f32 v16, v16, v14
    v_cvt_pk_bf16_f32 v16, v16, v16
    s_mov_b64 exec, 0xffff
    buffer_store_short v16, v36, s[60:63], s7 offen
    s_mov_b64 exec, -1
L_tend:
    s_add_u32 s76, s76, 1
    s_cmp_eq_u32 s76, 1
    s_cbranch_scc1 L_tail1
L_end:
    s_endpgm
.section .rodata,"a"
.p2align 6
.amdhsa_kernel recurrent_scan__gqa_block_cached__geglu_ffn__decode_kernel
  .amdhsa_next_free_vgpr 232
  .amdhsa_next_free_sgpr 102
  .amdhsa_accum_offset 232
  .amdhsa_group_segment_fixed_size 0
  .amdhsa_kernarg_size 96
  .amdhsa_user_sgpr_count 2
  .amdhsa_user_sgpr_kernarg_segment_ptr 1
  .amdhsa_system_sgpr_workgroup_id_x 1
.end_amdhsa_kernel
```
